```python
import torch

def _softmax(x, axis=-1):
    return torch.softmax(x, dim=axis)
def _gelu(x):
    return torch.nn.functional.gelu(x, approximate="tanh")
def _silu(x):
    return torch.nn.functional.silu(x)
def _sigmoid(x):
    return torch.sigmoid(x)
def _layernorm(x, axis=-1, eps=1e-5):
    m = x.mean(dim=axis, keepdim=True)
    v = x.var(dim=axis, keepdim=True, unbiased=False)
    return (x - m) / torch.sqrt(v + eps)
def _scatter_add(tgt, idx, src, axis=0):
    return tgt.clone().index_add_(axis, idx, src)
def _segment_sum(src, seg, n):
    out = torch.zeros((n,) + src.shape[1:], dtype=src.dtype)
    return out.index_add_(0, seg, src)
def _pad(x, pw):
    flat = tuple(v for pair in reversed(pw) for v in pair)
    return torch.nn.functional.pad(x, flat)

kernel_name = 'recurrent_scan__gqa_block_cached__mixer_token_mlp__decode'

def setup_inputs():

    _w = (lambda a: (lambda t: t.to(torch.bfloat16) if t.is_floating_point() else t)(torch.as_tensor(a)))
    def _A_setup():
        B, Sq, D = 1, 1, 512
        Hq, Hkv, Sk, Dh = 32, 8, 65536, 128
        assert Hq % Hkv == 0, (Hq, Hkv)
        return {
            "x": _w((lambda *s: torch.randn(*s, dtype=torch.bfloat16) * 0.4)(B, Sq, D)),
            "k_cache": _w((lambda *s: torch.randn(*s, dtype=torch.bfloat16) * 3.2)(B, Hkv, Sk, Dh)),
            "v_cache": _w((lambda *s: torch.randn(*s, dtype=torch.bfloat16) * 1.6)(B, Hkv, Sk, Dh)),
            "wq": _w((lambda *s: torch.randn(*s, dtype=torch.bfloat16) * 3.2)(D, Hq * Dh) * (D ** -0.5)),
            "wo": _w((lambda *s: torch.randn(*s, dtype=torch.bfloat16) * 1.6)(Hq * Dh, D) * ((Hq * Dh) ** -0.5)),
        }
    _A_in = _A_setup()

    def _B_setup():
        B, S, D, F = 1, 1, 512, 1792
        return {
            "x": _w((lambda *s: torch.randn(*s, dtype=torch.bfloat16) * 0.4)(B, S, D)),
            "w1": _w((lambda *s: torch.randn(*s, dtype=torch.bfloat16) * 1.6)(S, F) * (S ** -0.5)),
            "b1": _w((lambda *s: torch.randn(*s, dtype=torch.bfloat16) * 1.6)(F) * 0.02),
            "w2": _w((lambda *s: torch.randn(*s, dtype=torch.bfloat16) * 1.6)(F, S) * (F ** -0.5)),
            "b2": _w((lambda *s: torch.randn(*s, dtype=torch.bfloat16) * 1.6)(S) * 0.02),
        }
    _B_in = _B_setup()

    return {
        "A_x": _A_in["x"],
        "A_k_cache": _A_in["k_cache"],
        "A_v_cache": _A_in["v_cache"],
        "A_wq": _A_in["wq"],
        "A_wo": _A_in["wo"],
        "B_x": _B_in["x"],
        "B_w1": _B_in["w1"],
        "B_b1": _B_in["b1"],
        "B_w2": _B_in["w2"],
        "B_b2": _B_in["b2"],
    }

def reference(A_x, A_k_cache, A_v_cache, A_wq, A_wo, B_x, B_w1, B_b1, B_w2, B_b2):
    def _A_ref(x, k_cache, v_cache, wq, wo):
        B, Sq, D = x.shape
        Hq, Dh = 32, 128
        Hkv = k_cache.shape[1]
        rep = Hq // Hkv
        q = (lambda x, *d: x.permute(*d))((x @ wq).reshape(B, Sq, Hq, Dh), 0, 2, 1, 3)
        k = (lambda x, n, axis: torch.repeat_interleave(x, n, dim=axis))(k_cache, rep, axis=1)
        v = (lambda x, n, axis: torch.repeat_interleave(x, n, dim=axis))(v_cache, rep, axis=1)
        scores = torch.einsum("bhqd,bhkd->bhqk", q, k) * (Dh ** -0.5)
        p = _softmax(scores, axis=-1)
        o = torch.einsum("bhqk,bhkd->bhqd", p, v)
        return (lambda x, *d: x.permute(*d))(o, 0, 2, 1, 3).reshape(B, Sq, Hq * Dh) @ wo

    def _B_ref(x, w1, b1, w2, b2):
        B, S, D = x.shape
        h = _layernorm(x, axis=-1)
        u = torch.einsum("bsd,sf->bdf", h, w1) + b1
        u = _gelu(u)
        y = torch.einsum("bdf,fs->bds", u, w2) + b2
        return (lambda x, *d: x.permute(*d))(y, 0, 2, 1)

    x = A_x
    xn = _layernorm(x, axis=-1)
    s = _A_ref(xn, A_k_cache, A_v_cache, A_wq, A_wo)
    g = _silu(_B_ref(xn, B_w1, B_b1, B_w2, B_b2))
    return x + s * g
```

```asm
; @launch grid=(256,1,1) block=(320,1,1) lds=162304
.amdgcn_target "amdgcn-amd-amdhsa--gfx950"
.text
.globl recurrent_scan__gqa_block_cached__mixer_token_mlp__decode_kernel
.p2align 8
.type recurrent_scan__gqa_block_cached__mixer_token_mlp__decode_kernel,@function
recurrent_scan__gqa_block_cached__mixer_token_mlp__decode_kernel:
  s_cmp_ge_u32 s2, 256
  s_cbranch_scc1 L_end
  s_load_dwordx16 s[16:31], s[0:1], 0
  s_load_dwordx8 s[32:39], s[0:1], 64
  s_load_dwordx2 s[40:41], s[0:1], 96
  v_lshrrev_b32 v1, 6, v0
  s_and_b32 s42, s2, 7
  v_readfirstlane_b32 s3, v1
  s_lshr_b32 s43, s2, 3
  s_nop 2
  s_add_u32 s3, s3, 1
  s_cmp_eq_u32 s3, 5
  s_cselect_b32 s3, 0, s3
  v_and_b32 v1, 63, v0
  s_lshl_b32 s47, s42, 5
  s_add_u32 s47, s47, s43
  s_cmp_eq_u32 s3, 0
  s_cbranch_scc1 L_helper
  s_sub_u32 s3, s3, 1
  v_lshrrev_b32 v22, 4, v1
  v_and_b32 v23, 15, v1
  v_lshl_or_b32 v2, v22, 1, 0
  v_xor_b32 v2, v2, v23
  v_lshlrev_b32 v2, 4, v2
  v_lshl_or_b32 v2, v22, 8, v2
  v_lshl_or_b32 v3, v22, 1, 8
  v_xor_b32 v3, v3, v23
  v_lshlrev_b32 v3, 4, v3
  v_lshl_or_b32 v3, v22, 8, v3
  v_lshl_or_b32 v4, v22, 1, 1
  v_xor_b32 v4, v4, v23
  v_lshlrev_b32 v4, 4, v4
  v_lshl_or_b32 v4, v22, 8, v4
  v_lshl_or_b32 v5, v22, 1, 9
  v_xor_b32 v5, v5, v23
  v_lshlrev_b32 v5, 4, v5
  v_lshl_or_b32 v5, v22, 8, v5
  s_lshl_b32 s48, s3, 15
  s_lshl_b32 s49, s43, 2
  s_add_u32 s49, s49, s3
  s_lshl_b32 s49, s49, 12
  s_mul_i32 s60, s42, 1048576
  s_add_u32 s49, s49, s60
  s_lshr_b32 s60, s43, 4
  s_lshl_b32 s60, s60, 23
  s_add_u32 s49, s49, s60
  s_lshr_b32 s60, s43, 1
  s_lshl_b32 s60, s60, 2
  s_add_u32 s60, s60, s3
  s_lshl_b32 s60, s60, 12
  s_lshl_b32 s51, s42, 24
  s_waitcnt lgkmcnt(0)
  s_add_u32 s44, s18, s51
  s_addc_u32 s45, s19, 0
  s_and_b32 s45, s45, 0xffff
  s_mov_b32 s46, 16777216
  s_mov_b32 s47, 0x20000
  s_add_u32 s52, s20, s51
  s_addc_u32 s53, s21, 0
  s_and_b32 s53, s53, 0xffff
  s_mov_b32 s54, 16777216
  s_mov_b32 s55, 0x20000
  s_add_u32 s56, s49, 0
  s_and_b32 s56, s56, 0xffffff
  s_add_u32 m0, s48, 0
  s_nop 0
  buffer_load_dwordx4 v2, s[44:47], s56 offen offset:0 nt lds
  buffer_load_dwordx4 v3, s[44:47], s56 offen offset:1024 nt lds
  buffer_load_dwordx4 v4, s[44:47], s56 offen offset:2048 nt lds
  buffer_load_dwordx4 v5, s[44:47], s56 offen offset:3072 nt lds
  s_add_u32 s56, s49, 524288
  s_and_b32 s56, s56, 0xffffff
  s_add_u32 m0, s48, 4096
  s_nop 0
  buffer_load_dwordx4 v2, s[44:47], s56 offen offset:0 nt lds
  buffer_load_dwordx4 v3, s[44:47], s56 offen offset:1024 nt lds
  buffer_load_dwordx4 v4, s[44:47], s56 offen offset:2048 nt lds
  buffer_load_dwordx4 v5, s[44:47], s56 offen offset:3072 nt lds
  v_mov_b32 v82, 162000
  v_mov_b32 v83, 1
  s_mov_b32 s82, 0x4000000
  s_mov_b32 s83, 0
  s_barrier
  v_and_b32 v24, 7, v23
  v_lshlrev_b32 v24, 1, v24
  v_lshrrev_b32 v25, 3, v23
  v_or_b32 v24, v24, v25
  v_lshlrev_b32 v25, 8, v23
  v_add_u32 v25, s48, v25
  v_lshl_or_b32 v26, v22, 2, 0
  v_xor_b32 v26, v26, v24
  v_lshl_add_u32 v6, v26, 4, v25
  v_lshl_or_b32 v26, v22, 2, 1
  v_xor_b32 v26, v26, v24
  v_lshl_add_u32 v7, v26, 4, v25
  v_lshl_or_b32 v26, v22, 2, 2
  v_xor_b32 v26, v26, v24
  v_lshl_add_u32 v8, v26, 4, v25
  v_lshl_or_b32 v26, v22, 2, 3
  v_xor_b32 v26, v26, v24
  v_lshl_add_u32 v9, v26, 4, v25
  v_lshrrev_b32 v26, 2, v1
  v_and_b32 v24, 7, v26
  v_lshlrev_b32 v24, 1, v24
  v_lshrrev_b32 v25, 3, v26
  v_or_b32 v24, v24, v25
  v_bfe_u32 v27, v1, 1, 1
  v_xor_b32 v24, v24, v27
  v_and_b32 v27, 1, v1
  v_lshlrev_b32 v27, 3, v27
  v_lshl_add_u32 v25, v26, 8, v27
  v_add_u32 v25, s48, v25
  v_xor_b32 v26, 0, v24
  v_lshl_add_u32 v10, v26, 4, v25
  v_xor_b32 v26, 2, v24
  v_lshl_add_u32 v11, v26, 4, v25
  v_xor_b32 v26, 4, v24
  v_lshl_add_u32 v12, v26, 4, v25
  v_xor_b32 v26, 6, v24
  v_lshl_add_u32 v13, v26, 4, v25
  v_xor_b32 v26, 8, v24
  v_lshl_add_u32 v14, v26, 4, v25
  v_xor_b32 v26, 10, v24
  v_lshl_add_u32 v15, v26, 4, v25
  v_xor_b32 v26, 12, v24
  v_lshl_add_u32 v16, v26, 4, v25
  v_xor_b32 v26, 14, v24
  v_lshl_add_u32 v17, v26, 4, v25
  v_lshrrev_b32 v26, 2, v23
  v_cmp_eq_u32 vcc, 0, v26
  s_nop 1
  v_cndmask_b32 v18, 0, -1, vcc
  v_cmp_eq_u32 vcc, 1, v26
  s_nop 1
  v_cndmask_b32 v19, 0, -1, vcc
  v_cmp_eq_u32 vcc, 2, v26
  s_nop 1
  v_cndmask_b32 v20, 0, -1, vcc
  v_cmp_eq_u32 vcc, 3, v26
  s_nop 1
  v_cndmask_b32 v21, 0, -1, vcc
  v_and_b32 v26, 3, v1
  v_lshlrev_b32 v26, 8, v26
  v_lshl_add_u32 v26, v22, 6, v26
  v_add_u32 v23, 160768, v26
  s_mov_b32 s58, 0x3db504f3
  s_mov_b32 s59, 0x3fb8aa3b
  s_mov_b32 s61, 0xff80ff80
  s_add_u32 s56, s49, 1048576
  s_and_b32 s56, s56, 0xffffff
  s_add_u32 m0, s48, 8192
  s_waitcnt vmcnt(4)
  s_mov_b64 exec, 1
  ds_add_u32 v82, v83
L_sb1:
  ds_read_b64 v[80:81], v82
  s_sub_u32 s82, s82, 1
  s_cbranch_scc1 L_sd1
  s_waitcnt lgkmcnt(0)
  v_readfirstlane_b32 s57, v80
  v_readfirstlane_b32 s83, v81
  s_nop 2
  s_cmp_lt_u32 s57, 4
  s_cbranch_scc1 L_sb1
L_sd1:
  s_mov_b64 exec, -1
  buffer_load_dwordx4 v2, s[44:47], s56 offen offset:0 nt lds
  buffer_load_dwordx4 v3, s[44:47], s56 offen offset:1024 nt lds
  buffer_load_dwordx4 v4, s[44:47], s56 offen offset:2048 nt lds
  buffer_load_dwordx4 v5, s[44:47], s56 offen offset:3072 nt lds
  s_add_u32 s56, s49, 1572864
  s_and_b32 s56, s56, 0xffffff
  s_add_u32 m0, s48, 12288
  s_waitcnt vmcnt(4)
  s_mov_b64 exec, 1
  ds_add_u32 v82, v83
L_sb2:
  ds_read_b64 v[80:81], v82
  s_sub_u32 s82, s82, 1
  s_cbranch_scc1 L_sd2
  s_waitcnt lgkmcnt(0)
  v_readfirstlane_b32 s57, v80
  v_readfirstlane_b32 s83, v81
  s_nop 2
  s_cmp_lt_u32 s57, 8
  s_cbranch_scc1 L_sb2
L_sd2:
  s_mov_b64 exec, -1
  buffer_load_dwordx4 v2, s[44:47], s56 offen offset:0 nt lds
  buffer_load_dwordx4 v3, s[44:47], s56 offen offset:1024 nt lds
  buffer_load_dwordx4 v4, s[44:47], s56 offen offset:2048 nt lds
  buffer_load_dwordx4 v5, s[44:47], s56 offen offset:3072 nt lds
  s_add_u32 s56, s49, 2097152
  s_and_b32 s56, s56, 0xffffff
  s_add_u32 m0, s48, 16384
  s_waitcnt vmcnt(4)
  s_mov_b64 exec, 1
  ds_add_u32 v82, v83
L_sb3:
  ds_read_b64 v[80:81], v82
  s_sub_u32 s82, s82, 1
  s_cbranch_scc1 L_sd3
  s_waitcnt lgkmcnt(0)
  v_readfirstlane_b32 s57, v80
  v_readfirstlane_b32 s83, v81
  s_nop 2
  s_cmp_lt_u32 s57, 12
  s_cbranch_scc1 L_sb3
L_sd3:
  s_mov_b64 exec, -1
  buffer_load_dwordx4 v2, s[44:47], s56 offen offset:0 nt lds
  buffer_load_dwordx4 v3, s[44:47], s56 offen offset:1024 nt lds
  buffer_load_dwordx4 v4, s[44:47], s56 offen offset:2048 nt lds
  buffer_load_dwordx4 v5, s[44:47], s56 offen offset:3072 nt lds
  s_add_u32 s56, s49, 2621440
  s_and_b32 s56, s56, 0xffffff
  s_add_u32 m0, s48, 20480
  s_waitcnt vmcnt(4)
  s_mov_b64 exec, 1
  ds_add_u32 v82, v83
L_sb4:
  ds_read_b64 v[80:81], v82
  s_sub_u32 s82, s82, 1
  s_cbranch_scc1 L_sd4
  s_waitcnt lgkmcnt(0)
  v_readfirstlane_b32 s57, v80
  v_readfirstlane_b32 s83, v81
  s_nop 2
  s_cmp_lt_u32 s57, 16
  s_cbranch_scc1 L_sb4
L_sd4:
  s_mov_b64 exec, -1
  buffer_load_dwordx4 v2, s[44:47], s56 offen offset:0 nt lds
  buffer_load_dwordx4 v3, s[44:47], s56 offen offset:1024 nt lds
  buffer_load_dwordx4 v4, s[44:47], s56 offen offset:2048 nt lds
  buffer_load_dwordx4 v5, s[44:47], s56 offen offset:3072 nt lds
  s_add_u32 s56, s49, 3145728
  s_and_b32 s56, s56, 0xffffff
  s_add_u32 m0, s48, 24576
  s_waitcnt vmcnt(4)
  s_mov_b64 exec, 1
  ds_add_u32 v82, v83
L_sb5:
  ds_read_b64 v[80:81], v82
  s_sub_u32 s82, s82, 1
  s_cbranch_scc1 L_sd5
  s_waitcnt lgkmcnt(0)
  v_readfirstlane_b32 s57, v80
  v_readfirstlane_b32 s83, v81
  s_nop 2
  s_cmp_lt_u32 s57, 20
  s_cbranch_scc1 L_sb5
L_sd5:
  s_mov_b64 exec, -1
  buffer_load_dwordx4 v2, s[44:47], s56 offen offset:0 nt lds
  buffer_load_dwordx4 v3, s[44:47], s56 offen offset:1024 nt lds
  buffer_load_dwordx4 v4, s[44:47], s56 offen offset:2048 nt lds
  buffer_load_dwordx4 v5, s[44:47], s56 offen offset:3072 nt lds
  s_add_u32 s56, s49, 3670016
  s_and_b32 s56, s56, 0xffffff
  s_add_u32 m0, s48, 28672
  s_waitcnt vmcnt(4)
  s_mov_b64 exec, 1
  ds_add_u32 v82, v83
L_sb6:
  ds_read_b64 v[80:81], v82
  s_sub_u32 s82, s82, 1
  s_cbranch_scc1 L_sd6
  s_waitcnt lgkmcnt(0)
  v_readfirstlane_b32 s57, v80
  v_readfirstlane_b32 s83, v81
  s_nop 2
  s_cmp_lt_u32 s57, 24
  s_cbranch_scc1 L_sb6
L_sd6:
  s_mov_b64 exec, -1
  buffer_load_dwordx4 v2, s[44:47], s56 offen offset:0 nt lds
  buffer_load_dwordx4 v3, s[44:47], s56 offen offset:1024 nt lds
  buffer_load_dwordx4 v4, s[44:47], s56 offen offset:2048 nt lds
  buffer_load_dwordx4 v5, s[44:47], s56 offen offset:3072 nt lds
  s_waitcnt vmcnt(4)
  s_mov_b64 exec, 1
  ds_add_u32 v82, v83
L_sb7:
  ds_read_b64 v[80:81], v82
  s_sub_u32 s82, s82, 1
  s_cbranch_scc1 L_sd7
  s_waitcnt lgkmcnt(0)
  v_readfirstlane_b32 s57, v80
  v_readfirstlane_b32 s83, v81
  s_nop 2
  s_cmp_lt_u32 s57, 28
  s_cbranch_scc1 L_sb7
L_sd7:
  s_mov_b64 exec, -1
  ds_read_b128 v[96:99], v6 offset:0
  ds_read_b128 v[100:103], v7 offset:0
  ds_read_b128 v[104:107], v8 offset:0
  ds_read_b128 v[108:111], v9 offset:0
  s_waitcnt lgkmcnt(0)
  s_add_u32 s56, s49, 4194304
  s_and_b32 s56, s56, 0xffffff
  s_add_u32 m0, s48, 0
  s_nop 0
  buffer_load_dwordx4 v2, s[44:47], s56 offen offset:0 nt lds
  buffer_load_dwordx4 v3, s[44:47], s56 offen offset:1024 nt lds
  buffer_load_dwordx4 v4, s[44:47], s56 offen offset:2048 nt lds
  buffer_load_dwordx4 v5, s[44:47], s56 offen offset:3072 nt lds
  s_waitcnt vmcnt(4)
  s_mov_b64 exec, 1
  ds_add_u32 v82, v83
L_sb8:
  ds_read_b64 v[80:81], v82
  s_sub_u32 s82, s82, 1
  s_cbranch_scc1 L_sd8
  s_waitcnt lgkmcnt(0)
  v_readfirstlane_b32 s57, v80
  v_readfirstlane_b32 s83, v81
  s_nop 2
  s_cmp_lt_u32 s57, 32
  s_cbranch_scc1 L_sb8
L_sd8:
  s_mov_b64 exec, -1
  ds_read_b128 v[112:115], v6 offset:4096
  ds_read_b128 v[116:119], v7 offset:4096
  ds_read_b128 v[120:123], v8 offset:4096
  ds_read_b128 v[124:127], v9 offset:4096
  s_waitcnt lgkmcnt(0)
  s_add_u32 s56, s49, 4718592
  s_and_b32 s56, s56, 0xffffff
  s_add_u32 m0, s48, 4096
  s_nop 0
  buffer_load_dwordx4 v2, s[44:47], s56 offen offset:0 nt lds
  buffer_load_dwordx4 v3, s[44:47], s56 offen offset:1024 nt lds
  buffer_load_dwordx4 v4, s[44:47], s56 offen offset:2048 nt lds
  buffer_load_dwordx4 v5, s[44:47], s56 offen offset:3072 nt lds
  s_waitcnt vmcnt(4)
  s_mov_b64 exec, 1
  ds_add_u32 v82, v83
L_sb9:
  ds_read_b64 v[80:81], v82
  s_sub_u32 s82, s82, 1
  s_cbranch_scc1 L_sd9
  s_waitcnt lgkmcnt(0)
  v_readfirstlane_b32 s57, v80
  v_readfirstlane_b32 s83, v81
  s_nop 2
  s_cmp_lt_u32 s57, 36
  s_cbranch_scc1 L_sb9
L_sd9:
  s_mov_b64 exec, -1
  ds_read_b128 v[128:131], v6 offset:8192
  ds_read_b128 v[132:135], v7 offset:8192
  ds_read_b128 v[136:139], v8 offset:8192
  ds_read_b128 v[140:143], v9 offset:8192
  s_waitcnt lgkmcnt(0)
  s_add_u32 s56, s49, 5242880
  s_and_b32 s56, s56, 0xffffff
  s_add_u32 m0, s48, 8192
  s_nop 0
  buffer_load_dwordx4 v2, s[44:47], s56 offen offset:0 nt lds
  buffer_load_dwordx4 v3, s[44:47], s56 offen offset:1024 nt lds
  buffer_load_dwordx4 v4, s[44:47], s56 offen offset:2048 nt lds
  buffer_load_dwordx4 v5, s[44:47], s56 offen offset:3072 nt lds
  s_waitcnt vmcnt(4)
  s_mov_b64 exec, 1
  ds_add_u32 v82, v83
L_sb10:
  ds_read_b64 v[80:81], v82
  s_sub_u32 s82, s82, 1
  s_cbranch_scc1 L_sd10
  s_waitcnt lgkmcnt(0)
  v_readfirstlane_b32 s57, v80
  v_readfirstlane_b32 s83, v81
  s_nop 2
  s_cmp_lt_u32 s57, 40
  s_cbranch_scc1 L_sb10
L_sd10:
  s_mov_b64 exec, -1
  ds_read_b128 v[144:147], v6 offset:12288
  ds_read_b128 v[148:151], v7 offset:12288
  ds_read_b128 v[152:155], v8 offset:12288
  ds_read_b128 v[156:159], v9 offset:12288
  s_waitcnt lgkmcnt(0)
  s_add_u32 s56, s49, 5767168
  s_and_b32 s56, s56, 0xffffff
  s_add_u32 m0, s48, 12288
  s_nop 0
  buffer_load_dwordx4 v2, s[44:47], s56 offen offset:0 nt lds
  buffer_load_dwordx4 v3, s[44:47], s56 offen offset:1024 nt lds
  buffer_load_dwordx4 v4, s[44:47], s56 offen offset:2048 nt lds
  buffer_load_dwordx4 v5, s[44:47], s56 offen offset:3072 nt lds
  s_waitcnt vmcnt(4)
  s_mov_b64 exec, 1
  ds_add_u32 v82, v83
L_sb11:
  ds_read_b64 v[80:81], v82
  s_sub_u32 s82, s82, 1
  s_cbranch_scc1 L_sd11
  s_waitcnt lgkmcnt(0)
  v_readfirstlane_b32 s57, v80
  v_readfirstlane_b32 s83, v81
  s_nop 2
  s_cmp_lt_u32 s57, 44
  s_cbranch_scc1 L_sb11
L_sd11:
  s_mov_b64 exec, -1
  ds_read_b128 v[160:163], v6 offset:16384
  ds_read_b128 v[164:167], v7 offset:16384
  ds_read_b128 v[168:171], v8 offset:16384
  ds_read_b128 v[172:175], v9 offset:16384
  s_waitcnt lgkmcnt(0)
  s_add_u32 s56, s49, 6291456
  s_and_b32 s56, s56, 0xffffff
  s_add_u32 m0, s48, 16384
  s_nop 0
  buffer_load_dwordx4 v2, s[44:47], s56 offen offset:0 nt lds
  buffer_load_dwordx4 v3, s[44:47], s56 offen offset:1024 nt lds
  buffer_load_dwordx4 v4, s[44:47], s56 offen offset:2048 nt lds
  buffer_load_dwordx4 v5, s[44:47], s56 offen offset:3072 nt lds
  s_waitcnt vmcnt(4)
  s_mov_b64 exec, 1
  ds_add_u32 v82, v83
L_sb12:
  ds_read_b64 v[80:81], v82
  s_sub_u32 s82, s82, 1
  s_cbranch_scc1 L_sd12
  s_waitcnt lgkmcnt(0)
  v_readfirstlane_b32 s57, v80
  v_readfirstlane_b32 s83, v81
  s_nop 2
  s_cmp_lt_u32 s57, 48
  s_cbranch_scc1 L_sb12
L_sd12:
  s_mov_b64 exec, -1
  ds_read_b128 v[176:179], v6 offset:20480
  ds_read_b128 v[180:183], v7 offset:20480
  ds_read_b128 v[184:187], v8 offset:20480
  ds_read_b128 v[188:191], v9 offset:20480
  s_waitcnt lgkmcnt(0)
  s_add_u32 s56, s49, 6815744
  s_and_b32 s56, s56, 0xffffff
  s_add_u32 m0, s48, 20480
  s_nop 0
  buffer_load_dwordx4 v2, s[44:47], s56 offen offset:0 nt lds
  buffer_load_dwordx4 v3, s[44:47], s56 offen offset:1024 nt lds
  buffer_load_dwordx4 v4, s[44:47], s56 offen offset:2048 nt lds
  buffer_load_dwordx4 v5, s[44:47], s56 offen offset:3072 nt lds
  s_waitcnt vmcnt(4)
  s_mov_b64 exec, 1
  ds_add_u32 v82, v83
L_sb13:
  ds_read_b64 v[80:81], v82
  s_sub_u32 s82, s82, 1
  s_cbranch_scc1 L_sd13
  s_waitcnt lgkmcnt(0)
  v_readfirstlane_b32 s57, v80
  v_readfirstlane_b32 s83, v81
  s_nop 2
  s_cmp_lt_u32 s57, 52
  s_cbranch_scc1 L_sb13
L_sd13:
  s_mov_b64 exec, -1
  ds_read_b128 v[192:195], v6 offset:24576
  ds_read_b128 v[196:199], v7 offset:24576
  ds_read_b128 v[200:203], v8 offset:24576
  ds_read_b128 v[204:207], v9 offset:24576
  s_waitcnt lgkmcnt(0)
  s_add_u32 s56, s49, 7340032
  s_and_b32 s56, s56, 0xffffff
  s_add_u32 m0, s48, 24576
  s_nop 0
  buffer_load_dwordx4 v2, s[44:47], s56 offen offset:0 nt lds
  buffer_load_dwordx4 v3, s[44:47], s56 offen offset:1024 nt lds
  buffer_load_dwordx4 v4, s[44:47], s56 offen offset:2048 nt lds
  buffer_load_dwordx4 v5, s[44:47], s56 offen offset:3072 nt lds
  s_waitcnt vmcnt(4)
  s_mov_b64 exec, 1
  ds_add_u32 v82, v83
L_sb14:
  ds_read_b64 v[80:81], v82
  s_sub_u32 s82, s82, 1
  s_cbranch_scc1 L_sd14
  s_waitcnt lgkmcnt(0)
  v_readfirstlane_b32 s57, v80
  v_readfirstlane_b32 s83, v81
  s_nop 2
  s_cmp_lt_u32 s57, 56
  s_cbranch_scc1 L_sb14
L_sd14:
  s_mov_b64 exec, -1
  ds_read_b128 v[208:211], v6 offset:28672
  ds_read_b128 v[212:215], v7 offset:28672
  ds_read_b128 v[216:219], v8 offset:28672
  ds_read_b128 v[220:223], v9 offset:28672
  s_waitcnt lgkmcnt(0)
  s_add_u32 s56, s49, 7864320
  s_and_b32 s56, s56, 0xffffff
  s_add_u32 m0, s48, 28672
  s_nop 0
  buffer_load_dwordx4 v2, s[44:47], s56 offen offset:0 nt lds
  buffer_load_dwordx4 v3, s[44:47], s56 offen offset:1024 nt lds
  buffer_load_dwordx4 v4, s[44:47], s56 offen offset:2048 nt lds
  buffer_load_dwordx4 v5, s[44:47], s56 offen offset:3072 nt lds
  s_waitcnt vmcnt(4)
  s_mov_b64 exec, 1
  ds_add_u32 v82, v83
L_sb15:
  ds_read_b64 v[80:81], v82
  s_sub_u32 s82, s82, 1
  s_cbranch_scc1 L_sd15
  s_waitcnt lgkmcnt(0)
  v_readfirstlane_b32 s57, v80
  v_readfirstlane_b32 s83, v81
  s_nop 2
  s_cmp_lt_u32 s57, 60
  s_cbranch_scc1 L_sb15
L_sd15:
  s_mov_b64 exec, -1
  ds_read_b128 v[224:227], v6 offset:0
  ds_read_b128 v[228:231], v7 offset:0
  ds_read_b128 v[232:235], v8 offset:0
  ds_read_b128 v[236:239], v9 offset:0
  s_waitcnt lgkmcnt(0)
  s_add_u32 s56, s49, 8388608
  s_and_b32 s56, s56, 0xffffff
  s_add_u32 m0, s48, 0
  s_nop 0
  buffer_load_dwordx4 v2, s[44:47], s56 offen offset:0 nt lds
  buffer_load_dwordx4 v3, s[44:47], s56 offen offset:1024 nt lds
  buffer_load_dwordx4 v4, s[44:47], s56 offen offset:2048 nt lds
  buffer_load_dwordx4 v5, s[44:47], s56 offen offset:3072 nt lds
  s_waitcnt vmcnt(4)
  s_mov_b64 exec, 1
  ds_add_u32 v82, v83
L_sb16:
  ds_read_b64 v[80:81], v82
  s_sub_u32 s82, s82, 1
  s_cbranch_scc1 L_sd16
  s_waitcnt lgkmcnt(0)
  v_readfirstlane_b32 s57, v80
  v_readfirstlane_b32 s83, v81
  s_nop 2
  s_cmp_lt_u32 s57, 64
  s_cbranch_scc1 L_sb16
L_sd16:
  s_mov_b64 exec, -1
  ds_read_b128 v[240:243], v6 offset:4096
  ds_read_b128 v[244:247], v7 offset:4096
  ds_read_b128 v[248:251], v8 offset:4096
  ds_read_b128 v[252:255], v9 offset:4096
  s_waitcnt lgkmcnt(0)
  s_add_u32 s56, s49, 8912896
  s_and_b32 s56, s56, 0xffffff
  s_add_u32 m0, s48, 4096
  s_nop 0
  buffer_load_dwordx4 v2, s[44:47], s56 offen offset:0 nt lds
  buffer_load_dwordx4 v3, s[44:47], s56 offen offset:1024 nt lds
  buffer_load_dwordx4 v4, s[44:47], s56 offen offset:2048 nt lds
  buffer_load_dwordx4 v5, s[44:47], s56 offen offset:3072 nt lds
  s_barrier
  ds_read_b128 v[24:27], v23 offset:0
  ds_read_b128 v[28:31], v23 offset:16
  ds_read_b128 v[32:35], v23 offset:32
  ds_read_b128 v[36:39], v23 offset:48
  s_waitcnt lgkmcnt(0)
  v_and_b32 v40, v24, v18
  v_and_b32 v41, v25, v18
  v_and_b32 v42, v26, v18
  v_and_b32 v43, v27, v18
  v_and_b32 v44, v28, v18
  v_and_b32 v45, v29, v18
  v_and_b32 v46, v30, v18
  v_and_b32 v47, v31, v18
  v_and_b32 v48, v32, v18
  v_and_b32 v49, v33, v18
  v_and_b32 v50, v34, v18
  v_and_b32 v51, v35, v18
  v_and_b32 v52, v36, v18
  v_and_b32 v53, v37, v18
  v_and_b32 v54, v38, v18
  v_and_b32 v55, v39, v18
  s_waitcnt vmcnt(4)
  s_mov_b64 exec, 1
  ds_add_u32 v82, v83
L_sb17:
  ds_read_b64 v[80:81], v82
  s_sub_u32 s82, s82, 1
  s_cbranch_scc1 L_sd17
  s_waitcnt lgkmcnt(0)
  v_readfirstlane_b32 s57, v80
  v_readfirstlane_b32 s83, v81
  s_nop 2
  s_cmp_lt_u32 s57, 68
  s_cbranch_scc1 L_sb17
L_sd17:
  s_mov_b64 exec, -1
  s_nop 1
  v_mfma_f32_16x16x32_bf16 v[56:59], v[96:99], v[40:43], 0
  v_mfma_f32_16x16x32_bf16 v[56:59], v[100:103], v[44:47], v[56:59]
  v_mfma_f32_16x16x32_bf16 v[56:59], v[104:107], v[48:51], v[56:59]
  v_mfma_f32_16x16x32_bf16 v[56:59], v[108:111], v[52:55], v[56:59]
  v_mfma_f32_16x16x32_bf16 v[60:63], v[112:115], v[40:43], 0
  v_mfma_f32_16x16x32_bf16 v[60:63], v[116:119], v[44:47], v[60:63]
  v_mfma_f32_16x16x32_bf16 v[60:63], v[120:123], v[48:51], v[60:63]
  v_mfma_f32_16x16x32_bf16 v[60:63], v[124:127], v[52:55], v[60:63]
  ds_read_b128 v[96:99], v6 offset:8192
  ds_read_b128 v[100:103], v7 offset:8192
  ds_read_b128 v[104:107], v8 offset:8192
  ds_read_b128 v[108:111], v9 offset:8192
  s_waitcnt lgkmcnt(0)
  s_add_u32 s56, s49, 9437184
  s_and_b32 s56, s56, 0xffffff
  s_add_u32 m0, s48, 8192
  s_nop 0
  buffer_load_dwordx4 v2, s[44:47], s56 offen offset:0 nt lds
  buffer_load_dwordx4 v3, s[44:47], s56 offen offset:1024 nt lds
  buffer_load_dwordx4 v4, s[44:47], s56 offen offset:2048 nt lds
  buffer_load_dwordx4 v5, s[44:47], s56 offen offset:3072 nt lds
  v_and_b32 v40, v24, v19
  v_and_b32 v41, v25, v19
  v_and_b32 v42, v26, v19
  v_and_b32 v43, v27, v19
  v_and_b32 v44, v28, v19
  v_and_b32 v45, v29, v19
  v_and_b32 v46, v30, v19
  v_and_b32 v47, v31, v19
  v_and_b32 v48, v32, v19
  v_and_b32 v49, v33, v19
  v_and_b32 v50, v34, v19
  v_and_b32 v51, v35, v19
  v_and_b32 v52, v36, v19
  v_and_b32 v53, v37, v19
  v_and_b32 v54, v38, v19
  v_and_b32 v55, v39, v19
  s_waitcnt vmcnt(4)
  s_mov_b64 exec, 1
  ds_add_u32 v82, v83
L_sb18:
  ds_read_b64 v[80:81], v82
  s_sub_u32 s82, s82, 1
  s_cbranch_scc1 L_sd18
  s_waitcnt lgkmcnt(0)
  v_readfirstlane_b32 s57, v80
  v_readfirstlane_b32 s83, v81
  s_nop 2
  s_cmp_lt_u32 s57, 72
  s_cbranch_scc1 L_sb18
L_sd18:
  s_mov_b64 exec, -1
  s_nop 1
  v_mfma_f32_16x16x32_bf16 v[56:59], v[128:131], v[40:43], v[56:59]
  v_mfma_f32_16x16x32_bf16 v[56:59], v[132:135], v[44:47], v[56:59]
  v_mfma_f32_16x16x32_bf16 v[56:59], v[136:139], v[48:51], v[56:59]
  v_mfma_f32_16x16x32_bf16 v[56:59], v[140:143], v[52:55], v[56:59]
  v_mfma_f32_16x16x32_bf16 v[60:63], v[144:147], v[40:43], v[60:63]
  v_mfma_f32_16x16x32_bf16 v[60:63], v[148:151], v[44:47], v[60:63]
  v_mfma_f32_16x16x32_bf16 v[60:63], v[152:155], v[48:51], v[60:63]
  v_mfma_f32_16x16x32_bf16 v[60:63], v[156:159], v[52:55], v[60:63]
  ds_read_b128 v[112:115], v6 offset:12288
  ds_read_b128 v[116:119], v7 offset:12288
  ds_read_b128 v[120:123], v8 offset:12288
  ds_read_b128 v[124:127], v9 offset:12288
  s_waitcnt lgkmcnt(0)
  s_add_u32 s56, s49, 9961472
  s_and_b32 s56, s56, 0xffffff
  s_add_u32 m0, s48, 12288
  s_nop 0
  buffer_load_dwordx4 v2, s[44:47], s56 offen offset:0 nt lds
  buffer_load_dwordx4 v3, s[44:47], s56 offen offset:1024 nt lds
  buffer_load_dwordx4 v4, s[44:47], s56 offen offset:2048 nt lds
  buffer_load_dwordx4 v5, s[44:47], s56 offen offset:3072 nt lds
  v_and_b32 v40, v24, v20
  v_and_b32 v41, v25, v20
  v_and_b32 v42, v26, v20
  v_and_b32 v43, v27, v20
  v_and_b32 v44, v28, v20
  v_and_b32 v45, v29, v20
  v_and_b32 v46, v30, v20
  v_and_b32 v47, v31, v20
  v_and_b32 v48, v32, v20
  v_and_b32 v49, v33, v20
  v_and_b32 v50, v34, v20
  v_and_b32 v51, v35, v20
  v_and_b32 v52, v36, v20
  v_and_b32 v53, v37, v20
  v_and_b32 v54, v38, v20
  v_and_b32 v55, v39, v20
  s_waitcnt vmcnt(4)
  s_mov_b64 exec, 1
  ds_add_u32 v82, v83
L_sb19:
  ds_read_b64 v[80:81], v82
  s_sub_u32 s82, s82, 1
  s_cbranch_scc1 L_sd19
  s_waitcnt lgkmcnt(0)
  v_readfirstlane_b32 s57, v80
  v_readfirstlane_b32 s83, v81
  s_nop 2
  s_cmp_lt_u32 s57, 76
  s_cbranch_scc1 L_sb19
L_sd19:
  s_mov_b64 exec, -1
  s_nop 1
  v_mfma_f32_16x16x32_bf16 v[56:59], v[160:163], v[40:43], v[56:59]
  v_mfma_f32_16x16x32_bf16 v[56:59], v[164:167], v[44:47], v[56:59]
  v_mfma_f32_16x16x32_bf16 v[56:59], v[168:171], v[48:51], v[56:59]
  v_mfma_f32_16x16x32_bf16 v[56:59], v[172:175], v[52:55], v[56:59]
  v_mfma_f32_16x16x32_bf16 v[60:63], v[176:179], v[40:43], v[60:63]
  v_mfma_f32_16x16x32_bf16 v[60:63], v[180:183], v[44:47], v[60:63]
  v_mfma_f32_16x16x32_bf16 v[60:63], v[184:187], v[48:51], v[60:63]
  v_mfma_f32_16x16x32_bf16 v[60:63], v[188:191], v[52:55], v[60:63]
  ds_read_b128 v[128:131], v6 offset:16384
  ds_read_b128 v[132:135], v7 offset:16384
  ds_read_b128 v[136:139], v8 offset:16384
  ds_read_b128 v[140:143], v9 offset:16384
  s_waitcnt lgkmcnt(0)
  s_add_u32 s56, s49, 10485760
  s_and_b32 s56, s56, 0xffffff
  s_add_u32 m0, s48, 16384
  s_nop 0
  buffer_load_dwordx4 v2, s[44:47], s56 offen offset:0 nt lds
  buffer_load_dwordx4 v3, s[44:47], s56 offen offset:1024 nt lds
  buffer_load_dwordx4 v4, s[44:47], s56 offen offset:2048 nt lds
  buffer_load_dwordx4 v5, s[44:47], s56 offen offset:3072 nt lds
  v_and_b32 v40, v24, v21
  v_and_b32 v41, v25, v21
  v_and_b32 v42, v26, v21
  v_and_b32 v43, v27, v21
  v_and_b32 v44, v28, v21
  v_and_b32 v45, v29, v21
  v_and_b32 v46, v30, v21
  v_and_b32 v47, v31, v21
  v_and_b32 v48, v32, v21
  v_and_b32 v49, v33, v21
  v_and_b32 v50, v34, v21
  v_and_b32 v51, v35, v21
  v_and_b32 v52, v36, v21
  v_and_b32 v53, v37, v21
  v_and_b32 v54, v38, v21
  v_and_b32 v55, v39, v21
  s_waitcnt vmcnt(4)
  s_mov_b64 exec, 1
  ds_add_u32 v82, v83
L_sb20:
  ds_read_b64 v[80:81], v82
  s_sub_u32 s82, s82, 1
  s_cbranch_scc1 L_sd20
  s_waitcnt lgkmcnt(0)
  v_readfirstlane_b32 s57, v80
  v_readfirstlane_b32 s83, v81
  s_nop 2
  s_cmp_lt_u32 s57, 80
  s_cbranch_scc1 L_sb20
L_sd20:
  s_mov_b64 exec, -1
  s_nop 1
  v_mfma_f32_16x16x32_bf16 v[56:59], v[192:195], v[40:43], v[56:59]
  v_mfma_f32_16x16x32_bf16 v[56:59], v[196:199], v[44:47], v[56:59]
  v_mfma_f32_16x16x32_bf16 v[56:59], v[200:203], v[48:51], v[56:59]
  v_mfma_f32_16x16x32_bf16 v[56:59], v[204:207], v[52:55], v[56:59]
  v_mfma_f32_16x16x32_bf16 v[60:63], v[208:211], v[40:43], v[60:63]
  v_mfma_f32_16x16x32_bf16 v[60:63], v[212:215], v[44:47], v[60:63]
  v_mfma_f32_16x16x32_bf16 v[60:63], v[216:219], v[48:51], v[60:63]
  v_mfma_f32_16x16x32_bf16 v[60:63], v[220:223], v[52:55], v[60:63]
  ds_read_b128 v[144:147], v6 offset:20480
  ds_read_b128 v[148:151], v7 offset:20480
  ds_read_b128 v[152:155], v8 offset:20480
  ds_read_b128 v[156:159], v9 offset:20480
  s_waitcnt lgkmcnt(0)
  s_add_u32 s56, s49, 11010048
  s_and_b32 s56, s56, 0xffffff
  s_add_u32 m0, s48, 20480
  s_nop 0
  buffer_load_dwordx4 v2, s[44:47], s56 offen offset:0 nt lds
  buffer_load_dwordx4 v3, s[44:47], s56 offen offset:1024 nt lds
  buffer_load_dwordx4 v4, s[44:47], s56 offen offset:2048 nt lds
  buffer_load_dwordx4 v5, s[44:47], s56 offen offset:3072 nt lds
  s_nop 5
  v_cvt_pk_bf16_f32 v84, v56, v57
  v_cvt_pk_bf16_f32 v85, v58, v59
  v_cvt_pk_bf16_f32 v86, v60, v61
  v_cvt_pk_bf16_f32 v87, v62, v63
  v_lshlrev_b32 v88, 16, v84
  v_and_b32 v89, 0xffff0000, v84
  v_lshlrev_b32 v90, 16, v85
  v_and_b32 v91, 0xffff0000, v85
  v_lshlrev_b32 v92, 16, v86
  v_and_b32 v93, 0xffff0000, v86
  v_lshlrev_b32 v94, 16, v87
  v_and_b32 v95, 0xffff0000, v87
  v_mul_f32 v88, s58, v88
  v_mul_f32 v89, s58, v89
  v_mul_f32 v90, s58, v90
  v_mul_f32 v91, s58, v91
  v_mul_f32 v92, s58, v92
  v_mul_f32 v93, s58, v93
  v_mul_f32 v94, s58, v94
  v_mul_f32 v95, s58, v95
  v_cvt_pk_bf16_f32 v64, v88, v89
  v_cvt_pk_bf16_f32 v65, v90, v91
  v_cvt_pk_bf16_f32 v66, v92, v93
  v_cvt_pk_bf16_f32 v67, v94, v95
  v_and_b32 v40, v24, v18
  v_and_b32 v41, v25, v18
  v_and_b32 v42, v26, v18
  v_and_b32 v43, v27, v18
  v_and_b32 v44, v28, v18
  v_and_b32 v45, v29, v18
  v_and_b32 v46, v30, v18
  v_and_b32 v47, v31, v18
  v_and_b32 v48, v32, v18
  v_and_b32 v49, v33, v18
  v_and_b32 v50, v34, v18
  v_and_b32 v51, v35, v18
  v_and_b32 v52, v36, v18
  v_and_b32 v53, v37, v18
  v_and_b32 v54, v38, v18
  v_and_b32 v55, v39, v18
  s_waitcnt vmcnt(4)
  s_mov_b64 exec, 1
  ds_add_u32 v82, v83
L_sb21:
  ds_read_b64 v[80:81], v82
  s_sub_u32 s82, s82, 1
  s_cbranch_scc1 L_sd21
  s_waitcnt lgkmcnt(0)
  v_readfirstlane_b32 s57, v80
  v_readfirstlane_b32 s83, v81
  s_nop 2
  s_cmp_lt_u32 s57, 84
  s_cbranch_scc1 L_sb21
L_sd21:
  s_mov_b64 exec, -1
  s_nop 1
  v_mfma_f32_16x16x32_bf16 v[56:59], v[224:227], v[40:43], 0
  v_mfma_f32_16x16x32_bf16 v[56:59], v[228:231], v[44:47], v[56:59]
  v_mfma_f32_16x16x32_bf16 v[56:59], v[232:235], v[48:51], v[56:59]
  v_mfma_f32_16x16x32_bf16 v[56:59], v[236:239], v[52:55], v[56:59]
  v_mfma_f32_16x16x32_bf16 v[60:63], v[240:243], v[40:43], 0
  v_mfma_f32_16x16x32_bf16 v[60:63], v[244:247], v[44:47], v[60:63]
  v_mfma_f32_16x16x32_bf16 v[60:63], v[248:251], v[48:51], v[60:63]
  v_mfma_f32_16x16x32_bf16 v[60:63], v[252:255], v[52:55], v[60:63]
  ds_read_b128 v[160:163], v6 offset:24576
  ds_read_b128 v[164:167], v7 offset:24576
  ds_read_b128 v[168:171], v8 offset:24576
  ds_read_b128 v[172:175], v9 offset:24576
  s_waitcnt lgkmcnt(0)
  s_add_u32 s56, s49, 11534336
  s_and_b32 s56, s56, 0xffffff
  s_add_u32 m0, s48, 24576
  s_nop 0
  buffer_load_dwordx4 v2, s[44:47], s56 offen offset:0 nt lds
  buffer_load_dwordx4 v3, s[44:47], s56 offen offset:1024 nt lds
  buffer_load_dwordx4 v4, s[44:47], s56 offen offset:2048 nt lds
  buffer_load_dwordx4 v5, s[44:47], s56 offen offset:3072 nt lds
  v_and_b32 v40, v24, v19
  v_and_b32 v41, v25, v19
  v_and_b32 v42, v26, v19
  v_and_b32 v43, v27, v19
  v_and_b32 v44, v28, v19
  v_and_b32 v45, v29, v19
  v_and_b32 v46, v30, v19
  v_and_b32 v47, v31, v19
  v_and_b32 v48, v32, v19
  v_and_b32 v49, v33, v19
  v_and_b32 v50, v34, v19
  v_and_b32 v51, v35, v19
  v_and_b32 v52, v36, v19
  v_and_b32 v53, v37, v19
  v_and_b32 v54, v38, v19
  v_and_b32 v55, v39, v19
  s_waitcnt vmcnt(4)
  s_mov_b64 exec, 1
  ds_add_u32 v82, v83
L_sb22:
  ds_read_b64 v[80:81], v82
  s_sub_u32 s82, s82, 1
  s_cbranch_scc1 L_sd22
  s_waitcnt lgkmcnt(0)
  v_readfirstlane_b32 s57, v80
  v_readfirstlane_b32 s83, v81
  s_nop 2
  s_cmp_lt_u32 s57, 88
  s_cbranch_scc1 L_sb22
L_sd22:
  s_mov_b64 exec, -1
  s_nop 1
  v_mfma_f32_16x16x32_bf16 v[56:59], v[96:99], v[40:43], v[56:59]
  v_mfma_f32_16x16x32_bf16 v[56:59], v[100:103], v[44:47], v[56:59]
  v_mfma_f32_16x16x32_bf16 v[56:59], v[104:107], v[48:51], v[56:59]
  v_mfma_f32_16x16x32_bf16 v[56:59], v[108:111], v[52:55], v[56:59]
  v_mfma_f32_16x16x32_bf16 v[60:63], v[112:115], v[40:43], v[60:63]
  v_mfma_f32_16x16x32_bf16 v[60:63], v[116:119], v[44:47], v[60:63]
  v_mfma_f32_16x16x32_bf16 v[60:63], v[120:123], v[48:51], v[60:63]
  v_mfma_f32_16x16x32_bf16 v[60:63], v[124:127], v[52:55], v[60:63]
  ds_read_b128 v[176:179], v6 offset:28672
  ds_read_b128 v[180:183], v7 offset:28672
  ds_read_b128 v[184:187], v8 offset:28672
  ds_read_b128 v[188:191], v9 offset:28672
  s_waitcnt lgkmcnt(0)
  s_add_u32 s56, s49, 12058624
  s_and_b32 s56, s56, 0xffffff
  s_add_u32 m0, s48, 28672
  s_nop 0
  buffer_load_dwordx4 v2, s[44:47], s56 offen offset:0 nt lds
  buffer_load_dwordx4 v3, s[44:47], s56 offen offset:1024 nt lds
  buffer_load_dwordx4 v4, s[44:47], s56 offen offset:2048 nt lds
  buffer_load_dwordx4 v5, s[44:47], s56 offen offset:3072 nt lds
  v_and_b32 v40, v24, v20
  v_and_b32 v41, v25, v20
  v_and_b32 v42, v26, v20
  v_and_b32 v43, v27, v20
  v_and_b32 v44, v28, v20
  v_and_b32 v45, v29, v20
  v_and_b32 v46, v30, v20
  v_and_b32 v47, v31, v20
  v_and_b32 v48, v32, v20
  v_and_b32 v49, v33, v20
  v_and_b32 v50, v34, v20
  v_and_b32 v51, v35, v20
  v_and_b32 v52, v36, v20
  v_and_b32 v53, v37, v20
  v_and_b32 v54, v38, v20
  v_and_b32 v55, v39, v20
  s_waitcnt vmcnt(4)
  s_mov_b64 exec, 1
  ds_add_u32 v82, v83
L_sb23:
  ds_read_b64 v[80:81], v82
  s_sub_u32 s82, s82, 1
  s_cbranch_scc1 L_sd23
  s_waitcnt lgkmcnt(0)
  v_readfirstlane_b32 s57, v80
  v_readfirstlane_b32 s83, v81
  s_nop 2
  s_cmp_lt_u32 s57, 92
  s_cbranch_scc1 L_sb23
L_sd23:
  s_mov_b64 exec, -1
  s_nop 1
  v_mfma_f32_16x16x32_bf16 v[56:59], v[128:131], v[40:43], v[56:59]
  v_mfma_f32_16x16x32_bf16 v[56:59], v[132:135], v[44:47], v[56:59]
  v_mfma_f32_16x16x32_bf16 v[56:59], v[136:139], v[48:51], v[56:59]
  v_mfma_f32_16x16x32_bf16 v[56:59], v[140:143], v[52:55], v[56:59]
  v_mfma_f32_16x16x32_bf16 v[60:63], v[144:147], v[40:43], v[60:63]
  v_mfma_f32_16x16x32_bf16 v[60:63], v[148:151], v[44:47], v[60:63]
  v_mfma_f32_16x16x32_bf16 v[60:63], v[152:155], v[48:51], v[60:63]
  v_mfma_f32_16x16x32_bf16 v[60:63], v[156:159], v[52:55], v[60:63]
  ds_read_b128 v[192:195], v6 offset:0
  ds_read_b128 v[196:199], v7 offset:0
  ds_read_b128 v[200:203], v8 offset:0
  ds_read_b128 v[204:207], v9 offset:0
  s_waitcnt lgkmcnt(0)
  s_add_u32 s56, s49, 12582912
  s_and_b32 s56, s56, 0xffffff
  s_add_u32 m0, s48, 0
  s_nop 0
  buffer_load_dwordx4 v2, s[44:47], s56 offen offset:0 nt lds
  buffer_load_dwordx4 v3, s[44:47], s56 offen offset:1024 nt lds
  buffer_load_dwordx4 v4, s[44:47], s56 offen offset:2048 nt lds
  buffer_load_dwordx4 v5, s[44:47], s56 offen offset:3072 nt lds
  v_and_b32 v40, v24, v21
  v_and_b32 v41, v25, v21
  v_and_b32 v42, v26, v21
  v_and_b32 v43, v27, v21
  v_and_b32 v44, v28, v21
  v_and_b32 v45, v29, v21
  v_and_b32 v46, v30, v21
  v_and_b32 v47, v31, v21
  v_and_b32 v48, v32, v21
  v_and_b32 v49, v33, v21
  v_and_b32 v50, v34, v21
  v_and_b32 v51, v35, v21
  v_and_b32 v52, v36, v21
  v_and_b32 v53, v37, v21
  v_and_b32 v54, v38, v21
  v_and_b32 v55, v39, v21
  s_waitcnt vmcnt(4)
  s_mov_b64 exec, 1
  ds_add_u32 v82, v83
L_sb24:
  ds_read_b64 v[80:81], v82
  s_sub_u32 s82, s82, 1
  s_cbranch_scc1 L_sd24
  s_waitcnt lgkmcnt(0)
  v_readfirstlane_b32 s57, v80
  v_readfirstlane_b32 s83, v81
  s_nop 2
  s_cmp_lt_u32 s57, 96
  s_cbranch_scc1 L_sb24
L_sd24:
  s_mov_b64 exec, -1
  s_nop 1
  v_mfma_f32_16x16x32_bf16 v[56:59], v[160:163], v[40:43], v[56:59]
  v_mfma_f32_16x16x32_bf16 v[56:59], v[164:167], v[44:47], v[56:59]
  v_mfma_f32_16x16x32_bf16 v[56:59], v[168:171], v[48:51], v[56:59]
  v_mfma_f32_16x16x32_bf16 v[56:59], v[172:175], v[52:55], v[56:59]
  v_mfma_f32_16x16x32_bf16 v[60:63], v[176:179], v[40:43], v[60:63]
  v_mfma_f32_16x16x32_bf16 v[60:63], v[180:183], v[44:47], v[60:63]
  v_mfma_f32_16x16x32_bf16 v[60:63], v[184:187], v[48:51], v[60:63]
  v_mfma_f32_16x16x32_bf16 v[60:63], v[188:191], v[52:55], v[60:63]
  ds_read_b128 v[208:211], v6 offset:4096
  ds_read_b128 v[212:215], v7 offset:4096
  ds_read_b128 v[216:219], v8 offset:4096
  ds_read_b128 v[220:223], v9 offset:4096
  s_waitcnt lgkmcnt(0)
  s_add_u32 s56, s49, 13107200
  s_and_b32 s56, s56, 0xffffff
  s_add_u32 m0, s48, 4096
  s_nop 0
  buffer_load_dwordx4 v2, s[44:47], s56 offen offset:0 nt lds
  buffer_load_dwordx4 v3, s[44:47], s56 offen offset:1024 nt lds
  buffer_load_dwordx4 v4, s[44:47], s56 offen offset:2048 nt lds
  buffer_load_dwordx4 v5, s[44:47], s56 offen offset:3072 nt lds
  s_nop 5
  v_cvt_pk_bf16_f32 v84, v56, v57
  v_cvt_pk_bf16_f32 v85, v58, v59
  v_cvt_pk_bf16_f32 v86, v60, v61
  v_cvt_pk_bf16_f32 v87, v62, v63
  v_lshlrev_b32 v88, 16, v84
  v_and_b32 v89, 0xffff0000, v84
  v_lshlrev_b32 v90, 16, v85
  v_and_b32 v91, 0xffff0000, v85
  v_lshlrev_b32 v92, 16, v86
  v_and_b32 v93, 0xffff0000, v86
  v_lshlrev_b32 v94, 16, v87
  v_and_b32 v95, 0xffff0000, v87
  v_mul_f32 v88, s58, v88
  v_mul_f32 v89, s58, v89
  v_mul_f32 v90, s58, v90
  v_mul_f32 v91, s58, v91
  v_mul_f32 v92, s58, v92
  v_mul_f32 v93, s58, v93
  v_mul_f32 v94, s58, v94
  v_mul_f32 v95, s58, v95
  v_cvt_pk_bf16_f32 v68, v88, v89
  v_cvt_pk_bf16_f32 v69, v90, v91
  v_cvt_pk_bf16_f32 v70, v92, v93
  v_cvt_pk_bf16_f32 v71, v94, v95
  v_and_b32 v40, v24, v18
  v_and_b32 v41, v25, v18
  v_and_b32 v42, v26, v18
  v_and_b32 v43, v27, v18
  v_and_b32 v44, v28, v18
  v_and_b32 v45, v29, v18
  v_and_b32 v46, v30, v18
  v_and_b32 v47, v31, v18
  v_and_b32 v48, v32, v18
  v_and_b32 v49, v33, v18
  v_and_b32 v50, v34, v18
  v_and_b32 v51, v35, v18
  v_and_b32 v52, v36, v18
  v_and_b32 v53, v37, v18
  v_and_b32 v54, v38, v18
  v_and_b32 v55, v39, v18
  s_waitcnt vmcnt(4)
  s_mov_b64 exec, 1
  ds_add_u32 v82, v83
L_sb25:
  ds_read_b64 v[80:81], v82
  s_sub_u32 s82, s82, 1
  s_cbranch_scc1 L_sd25
  s_waitcnt lgkmcnt(0)
  v_readfirstlane_b32 s57, v80
  v_readfirstlane_b32 s83, v81
  s_nop 2
  s_cmp_lt_u32 s57, 100
  s_cbranch_scc1 L_sb25
L_sd25:
  s_mov_b64 exec, -1
  s_nop 1
  v_mfma_f32_16x16x32_bf16 v[56:59], v[192:195], v[40:43], 0
  v_mfma_f32_16x16x32_bf16 v[56:59], v[196:199], v[44:47], v[56:59]
  v_mfma_f32_16x16x32_bf16 v[56:59], v[200:203], v[48:51], v[56:59]
  v_mfma_f32_16x16x32_bf16 v[56:59], v[204:207], v[52:55], v[56:59]
  v_mfma_f32_16x16x32_bf16 v[60:63], v[208:211], v[40:43], 0
  v_mfma_f32_16x16x32_bf16 v[60:63], v[212:215], v[44:47], v[60:63]
  v_mfma_f32_16x16x32_bf16 v[60:63], v[216:219], v[48:51], v[60:63]
  v_mfma_f32_16x16x32_bf16 v[60:63], v[220:223], v[52:55], v[60:63]
  ds_read_b128 v[224:227], v6 offset:8192
  ds_read_b128 v[228:231], v7 offset:8192
  ds_read_b128 v[232:235], v8 offset:8192
  ds_read_b128 v[236:239], v9 offset:8192
  s_waitcnt lgkmcnt(0)
  s_add_u32 s56, s49, 13631488
  s_and_b32 s56, s56, 0xffffff
  s_add_u32 m0, s48, 8192
  s_nop 0
  buffer_load_dwordx4 v2, s[44:47], s56 offen offset:0 nt lds
  buffer_load_dwordx4 v3, s[44:47], s56 offen offset:1024 nt lds
  buffer_load_dwordx4 v4, s[44:47], s56 offen offset:2048 nt lds
  buffer_load_dwordx4 v5, s[44:47], s56 offen offset:3072 nt lds
  v_and_b32 v40, v24, v19
  v_and_b32 v41, v25, v19
  v_and_b32 v42, v26, v19
  v_and_b32 v43, v27, v19
  v_and_b32 v44, v28, v19
  v_and_b32 v45, v29, v19
  v_and_b32 v46, v30, v19
  v_and_b32 v47, v31, v19
  v_and_b32 v48, v32, v19
  v_and_b32 v49, v33, v19
  v_and_b32 v50, v34, v19
  v_and_b32 v51, v35, v19
  v_and_b32 v52, v36, v19
  v_and_b32 v53, v37, v19
  v_and_b32 v54, v38, v19
  v_and_b32 v55, v39, v19
  s_waitcnt vmcnt(4)
  s_mov_b64 exec, 1
  ds_add_u32 v82, v83
L_sb26:
  ds_read_b64 v[80:81], v82
  s_sub_u32 s82, s82, 1
  s_cbranch_scc1 L_sd26
  s_waitcnt lgkmcnt(0)
  v_readfirstlane_b32 s57, v80
  v_readfirstlane_b32 s83, v81
  s_nop 2
  s_cmp_lt_u32 s57, 104
  s_cbranch_scc1 L_sb26
L_sd26:
  s_mov_b64 exec, -1
  ds_read_b128 v[240:243], v6 offset:12288
  ds_read_b128 v[244:247], v7 offset:12288
  ds_read_b128 v[248:251], v8 offset:12288
  ds_read_b128 v[252:255], v9 offset:12288
  s_waitcnt lgkmcnt(0)
  s_add_u32 s56, s49, 14155776
  s_and_b32 s56, s56, 0xffffff
  s_add_u32 m0, s48, 12288
  s_nop 0
  buffer_load_dwordx4 v2, s[44:47], s56 offen offset:0 nt lds
  buffer_load_dwordx4 v3, s[44:47], s56 offen offset:1024 nt lds
  buffer_load_dwordx4 v4, s[44:47], s56 offen offset:2048 nt lds
  buffer_load_dwordx4 v5, s[44:47], s56 offen offset:3072 nt lds
  s_waitcnt vmcnt(4)
  s_mov_b64 exec, 1
  ds_add_u32 v82, v83
L_sb27:
  ds_read_b64 v[80:81], v82
  s_sub_u32 s82, s82, 1
  s_cbranch_scc1 L_sd27
  s_waitcnt lgkmcnt(0)
  v_readfirstlane_b32 s57, v80
  v_readfirstlane_b32 s83, v81
  s_nop 2
  s_cmp_lt_u32 s57, 108
  s_cbranch_scc1 L_sb27
L_sd27:
  s_mov_b64 exec, -1
  s_nop 1
  v_mfma_f32_16x16x32_bf16 v[56:59], v[224:227], v[40:43], v[56:59]
  v_mfma_f32_16x16x32_bf16 v[56:59], v[228:231], v[44:47], v[56:59]
  v_mfma_f32_16x16x32_bf16 v[56:59], v[232:235], v[48:51], v[56:59]
  v_mfma_f32_16x16x32_bf16 v[56:59], v[236:239], v[52:55], v[56:59]
  v_mfma_f32_16x16x32_bf16 v[60:63], v[240:243], v[40:43], v[60:63]
  v_mfma_f32_16x16x32_bf16 v[60:63], v[244:247], v[44:47], v[60:63]
  v_mfma_f32_16x16x32_bf16 v[60:63], v[248:251], v[48:51], v[60:63]
  v_mfma_f32_16x16x32_bf16 v[60:63], v[252:255], v[52:55], v[60:63]
  ds_read_b128 v[96:99], v6 offset:16384
  ds_read_b128 v[100:103], v7 offset:16384
  ds_read_b128 v[104:107], v8 offset:16384
  ds_read_b128 v[108:111], v9 offset:16384
  s_waitcnt lgkmcnt(0)
  s_add_u32 s56, s49, 14680064
  s_and_b32 s56, s56, 0xffffff
  s_add_u32 m0, s48, 16384
  s_nop 0
  buffer_load_dwordx4 v2, s[44:47], s56 offen offset:0 nt lds
  buffer_load_dwordx4 v3, s[44:47], s56 offen offset:1024 nt lds
  buffer_load_dwordx4 v4, s[44:47], s56 offen offset:2048 nt lds
  buffer_load_dwordx4 v5, s[44:47], s56 offen offset:3072 nt lds
  v_and_b32 v40, v24, v20
  v_and_b32 v41, v25, v20
  v_and_b32 v42, v26, v20
  v_and_b32 v43, v27, v20
  v_and_b32 v44, v28, v20
  v_and_b32 v45, v29, v20
  v_and_b32 v46, v30, v20
  v_and_b32 v47, v31, v20
  v_and_b32 v48, v32, v20
  v_and_b32 v49, v33, v20
  v_and_b32 v50, v34, v20
  v_and_b32 v51, v35, v20
  v_and_b32 v52, v36, v20
  v_and_b32 v53, v37, v20
  v_and_b32 v54, v38, v20
  v_and_b32 v55, v39, v20
  s_waitcnt vmcnt(4)
  s_mov_b64 exec, 1
  ds_add_u32 v82, v83
L_sb28:
  ds_read_b64 v[80:81], v82
  s_sub_u32 s82, s82, 1
  s_cbranch_scc1 L_sd28
  s_waitcnt lgkmcnt(0)
  v_readfirstlane_b32 s57, v80
  v_readfirstlane_b32 s83, v81
  s_nop 2
  s_cmp_lt_u32 s57, 112
  s_cbranch_scc1 L_sb28
L_sd28:
  s_mov_b64 exec, -1
  ds_read_b128 v[112:115], v6 offset:20480
  ds_read_b128 v[116:119], v7 offset:20480
  ds_read_b128 v[120:123], v8 offset:20480
  ds_read_b128 v[124:127], v9 offset:20480
  s_waitcnt lgkmcnt(0)
  s_add_u32 s56, s49, 15204352
  s_and_b32 s56, s56, 0xffffff
  s_add_u32 m0, s48, 20480
  s_nop 0
  buffer_load_dwordx4 v2, s[44:47], s56 offen offset:0 nt lds
  buffer_load_dwordx4 v3, s[44:47], s56 offen offset:1024 nt lds
  buffer_load_dwordx4 v4, s[44:47], s56 offen offset:2048 nt lds
  buffer_load_dwordx4 v5, s[44:47], s56 offen offset:3072 nt lds
  s_waitcnt vmcnt(4)
  s_mov_b64 exec, 1
  ds_add_u32 v82, v83
L_sb29:
  ds_read_b64 v[80:81], v82
  s_sub_u32 s82, s82, 1
  s_cbranch_scc1 L_sd29
  s_waitcnt lgkmcnt(0)
  v_readfirstlane_b32 s57, v80
  v_readfirstlane_b32 s83, v81
  s_nop 2
  s_cmp_lt_u32 s57, 116
  s_cbranch_scc1 L_sb29
L_sd29:
  s_mov_b64 exec, -1
  s_nop 1
  v_mfma_f32_16x16x32_bf16 v[56:59], v[96:99], v[40:43], v[56:59]
  v_mfma_f32_16x16x32_bf16 v[56:59], v[100:103], v[44:47], v[56:59]
  v_mfma_f32_16x16x32_bf16 v[56:59], v[104:107], v[48:51], v[56:59]
  v_mfma_f32_16x16x32_bf16 v[56:59], v[108:111], v[52:55], v[56:59]
  v_mfma_f32_16x16x32_bf16 v[60:63], v[112:115], v[40:43], v[60:63]
  v_mfma_f32_16x16x32_bf16 v[60:63], v[116:119], v[44:47], v[60:63]
  v_mfma_f32_16x16x32_bf16 v[60:63], v[120:123], v[48:51], v[60:63]
  v_mfma_f32_16x16x32_bf16 v[60:63], v[124:127], v[52:55], v[60:63]
  ds_read_b128 v[128:131], v6 offset:24576
  ds_read_b128 v[132:135], v7 offset:24576
  ds_read_b128 v[136:139], v8 offset:24576
  ds_read_b128 v[140:143], v9 offset:24576
  s_waitcnt lgkmcnt(0)
  s_add_u32 s56, s49, 15728640
  s_and_b32 s56, s56, 0xffffff
  s_add_u32 m0, s48, 24576
  s_nop 0
  buffer_load_dwordx4 v2, s[44:47], s56 offen offset:0 nt lds
  buffer_load_dwordx4 v3, s[44:47], s56 offen offset:1024 nt lds
  buffer_load_dwordx4 v4, s[44:47], s56 offen offset:2048 nt lds
  buffer_load_dwordx4 v5, s[44:47], s56 offen offset:3072 nt lds
  v_and_b32 v40, v24, v21
  v_and_b32 v41, v25, v21
  v_and_b32 v42, v26, v21
  v_and_b32 v43, v27, v21
  v_and_b32 v44, v28, v21
  v_and_b32 v45, v29, v21
  v_and_b32 v46, v30, v21
  v_and_b32 v47, v31, v21
  v_and_b32 v48, v32, v21
  v_and_b32 v49, v33, v21
  v_and_b32 v50, v34, v21
  v_and_b32 v51, v35, v21
  v_and_b32 v52, v36, v21
  v_and_b32 v53, v37, v21
  v_and_b32 v54, v38, v21
  v_and_b32 v55, v39, v21
  s_waitcnt vmcnt(4)
  s_mov_b64 exec, 1
  ds_add_u32 v82, v83
L_sb30:
  ds_read_b64 v[80:81], v82
  s_sub_u32 s82, s82, 1
  s_cbranch_scc1 L_sd30
  s_waitcnt lgkmcnt(0)
  v_readfirstlane_b32 s57, v80
  v_readfirstlane_b32 s83, v81
  s_nop 2
  s_cmp_lt_u32 s57, 120
  s_cbranch_scc1 L_sb30
L_sd30:
  s_mov_b64 exec, -1
  ds_read_b128 v[144:147], v6 offset:28672
  ds_read_b128 v[148:151], v7 offset:28672
  ds_read_b128 v[152:155], v8 offset:28672
  ds_read_b128 v[156:159], v9 offset:28672
  s_waitcnt lgkmcnt(0)
  s_add_u32 s56, s49, 16252928
  s_and_b32 s56, s56, 0xffffff
  s_add_u32 m0, s48, 28672
  s_nop 0
  buffer_load_dwordx4 v2, s[44:47], s56 offen offset:0 nt lds
  buffer_load_dwordx4 v3, s[44:47], s56 offen offset:1024 nt lds
  buffer_load_dwordx4 v4, s[44:47], s56 offen offset:2048 nt lds
  buffer_load_dwordx4 v5, s[44:47], s56 offen offset:3072 nt lds
  s_waitcnt vmcnt(4)
  s_mov_b64 exec, 1
  ds_add_u32 v82, v83
L_sb31:
  ds_read_b64 v[80:81], v82
  s_sub_u32 s82, s82, 1
  s_cbranch_scc1 L_sd31
  s_waitcnt lgkmcnt(0)
  v_readfirstlane_b32 s57, v80
  v_readfirstlane_b32 s83, v81
  s_nop 2
  s_cmp_lt_u32 s57, 124
  s_cbranch_scc1 L_sb31
L_sd31:
  s_mov_b64 exec, -1
  s_nop 1
  v_mfma_f32_16x16x32_bf16 v[56:59], v[128:131], v[40:43], v[56:59]
  v_mfma_f32_16x16x32_bf16 v[56:59], v[132:135], v[44:47], v[56:59]
  v_mfma_f32_16x16x32_bf16 v[56:59], v[136:139], v[48:51], v[56:59]
  v_mfma_f32_16x16x32_bf16 v[56:59], v[140:143], v[52:55], v[56:59]
  v_mfma_f32_16x16x32_bf16 v[60:63], v[144:147], v[40:43], v[60:63]
  v_mfma_f32_16x16x32_bf16 v[60:63], v[148:151], v[44:47], v[60:63]
  v_mfma_f32_16x16x32_bf16 v[60:63], v[152:155], v[48:51], v[60:63]
  v_mfma_f32_16x16x32_bf16 v[60:63], v[156:159], v[52:55], v[60:63]
  ds_read_b128 v[160:163], v6 offset:0
  ds_read_b128 v[164:167], v7 offset:0
  ds_read_b128 v[168:171], v8 offset:0
  ds_read_b128 v[172:175], v9 offset:0
  s_waitcnt lgkmcnt(0)
  s_add_u32 s56, s49, 0
  s_and_b32 s56, s56, 0xffffff
  s_add_u32 m0, s48, 0
  s_nop 0
  buffer_load_dwordx4 v2, s[52:55], s56 offen offset:0 nt lds
  buffer_load_dwordx4 v3, s[52:55], s56 offen offset:1024 nt lds
  buffer_load_dwordx4 v4, s[52:55], s56 offen offset:2048 nt lds
  buffer_load_dwordx4 v5, s[52:55], s56 offen offset:3072 nt lds
  s_nop 5
  v_cvt_pk_bf16_f32 v84, v56, v57
  v_cvt_pk_bf16_f32 v85, v58, v59
  v_cvt_pk_bf16_f32 v86, v60, v61
  v_cvt_pk_bf16_f32 v87, v62, v63
  v_lshlrev_b32 v88, 16, v84
  v_and_b32 v89, 0xffff0000, v84
  v_lshlrev_b32 v90, 16, v85
  v_and_b32 v91, 0xffff0000, v85
  v_lshlrev_b32 v92, 16, v86
  v_and_b32 v93, 0xffff0000, v86
  v_lshlrev_b32 v94, 16, v87
  v_and_b32 v95, 0xffff0000, v87
  v_mul_f32 v88, s58, v88
  v_mul_f32 v89, s58, v89
  v_mul_f32 v90, s58, v90
  v_mul_f32 v91, s58, v91
  v_mul_f32 v92, s58, v92
  v_mul_f32 v93, s58, v93
  v_mul_f32 v94, s58, v94
  v_mul_f32 v95, s58, v95
  v_cvt_pk_bf16_f32 v72, v88, v89
  v_cvt_pk_bf16_f32 v73, v90, v91
  v_cvt_pk_bf16_f32 v74, v92, v93
  v_cvt_pk_bf16_f32 v75, v94, v95
  v_and_b32 v40, v24, v18
  v_and_b32 v41, v25, v18
  v_and_b32 v42, v26, v18
  v_and_b32 v43, v27, v18
  v_and_b32 v44, v28, v18
  v_and_b32 v45, v29, v18
  v_and_b32 v46, v30, v18
  v_and_b32 v47, v31, v18
  v_and_b32 v48, v32, v18
  v_and_b32 v49, v33, v18
  v_and_b32 v50, v34, v18
  v_and_b32 v51, v35, v18
  v_and_b32 v52, v36, v18
  v_and_b32 v53, v37, v18
  v_and_b32 v54, v38, v18
  v_and_b32 v55, v39, v18
  s_waitcnt vmcnt(4)
  s_mov_b64 exec, 1
  ds_add_u32 v82, v83
L_sb32:
  ds_read_b64 v[80:81], v82
  s_sub_u32 s82, s82, 1
  s_cbranch_scc1 L_sd32
  s_waitcnt lgkmcnt(0)
  v_readfirstlane_b32 s57, v80
  v_readfirstlane_b32 s83, v81
  s_nop 2
  s_cmp_lt_u32 s57, 128
  s_cbranch_scc1 L_sb32
L_sd32:
  s_mov_b64 exec, -1
  ds_read_b128 v[176:179], v6 offset:4096
  ds_read_b128 v[180:183], v7 offset:4096
  ds_read_b128 v[184:187], v8 offset:4096
  ds_read_b128 v[188:191], v9 offset:4096
  s_waitcnt lgkmcnt(0)
  s_add_u32 s56, s49, 524288
  s_and_b32 s56, s56, 0xffffff
  s_add_u32 m0, s48, 4096
  s_nop 0
  buffer_load_dwordx4 v2, s[52:55], s56 offen offset:0 nt lds
  buffer_load_dwordx4 v3, s[52:55], s56 offen offset:1024 nt lds
  buffer_load_dwordx4 v4, s[52:55], s56 offen offset:2048 nt lds
  buffer_load_dwordx4 v5, s[52:55], s56 offen offset:3072 nt lds
  s_waitcnt vmcnt(4)
  s_mov_b64 exec, 1
  ds_add_u32 v82, v83
L_sb33:
  ds_read_b64 v[80:81], v82
  s_sub_u32 s82, s82, 1
  s_cbranch_scc1 L_sd33
  s_waitcnt lgkmcnt(0)
  v_readfirstlane_b32 s57, v80
  v_readfirstlane_b32 s83, v81
  s_nop 2
  s_cmp_lt_u32 s57, 132
  s_cbranch_scc1 L_sb33
L_sd33:
  s_mov_b64 exec, -1
  s_nop 1
  v_mfma_f32_16x16x32_bf16 v[56:59], v[160:163], v[40:43], 0
  v_mfma_f32_16x16x32_bf16 v[56:59], v[164:167], v[44:47], v[56:59]
  v_mfma_f32_16x16x32_bf16 v[56:59], v[168:171], v[48:51], v[56:59]
  v_mfma_f32_16x16x32_bf16 v[56:59], v[172:175], v[52:55], v[56:59]
  v_mfma_f32_16x16x32_bf16 v[60:63], v[176:179], v[40:43], 0
  v_mfma_f32_16x16x32_bf16 v[60:63], v[180:183], v[44:47], v[60:63]
  v_mfma_f32_16x16x32_bf16 v[60:63], v[184:187], v[48:51], v[60:63]
  v_mfma_f32_16x16x32_bf16 v[60:63], v[188:191], v[52:55], v[60:63]
  ds_read_b128 v[192:195], v6 offset:8192
  ds_read_b128 v[196:199], v7 offset:8192
  ds_read_b128 v[200:203], v8 offset:8192
  ds_read_b128 v[204:207], v9 offset:8192
  s_waitcnt lgkmcnt(0)
  s_add_u32 s56, s49, 1048576
  s_and_b32 s56, s56, 0xffffff
  s_add_u32 m0, s48, 8192
  s_nop 0
  buffer_load_dwordx4 v2, s[52:55], s56 offen offset:0 nt lds
  buffer_load_dwordx4 v3, s[52:55], s56 offen offset:1024 nt lds
  buffer_load_dwordx4 v4, s[52:55], s56 offen offset:2048 nt lds
  buffer_load_dwordx4 v5, s[52:55], s56 offen offset:3072 nt lds
  v_and_b32 v40, v24, v19
  v_and_b32 v41, v25, v19
  v_and_b32 v42, v26, v19
  v_and_b32 v43, v27, v19
  v_and_b32 v44, v28, v19
  v_and_b32 v45, v29, v19
  v_and_b32 v46, v30, v19
  v_and_b32 v47, v31, v19
  v_and_b32 v48, v32, v19
  v_and_b32 v49, v33, v19
  v_and_b32 v50, v34, v19
  v_and_b32 v51, v35, v19
  v_and_b32 v52, v36, v19
  v_and_b32 v53, v37, v19
  v_and_b32 v54, v38, v19
  v_and_b32 v55, v39, v19
  s_waitcnt vmcnt(4)
  s_mov_b64 exec, 1
  ds_add_u32 v82, v83
L_sb34:
  ds_read_b64 v[80:81], v82
  s_sub_u32 s82, s82, 1
  s_cbranch_scc1 L_sd34
  s_waitcnt lgkmcnt(0)
  v_readfirstlane_b32 s57, v80
  v_readfirstlane_b32 s83, v81
  s_nop 2
  s_cmp_lt_u32 s57, 136
  s_cbranch_scc1 L_sb34
L_sd34:
  s_mov_b64 exec, -1
  ds_read_b128 v[208:211], v6 offset:12288
  ds_read_b128 v[212:215], v7 offset:12288
  ds_read_b128 v[216:219], v8 offset:12288
  ds_read_b128 v[220:223], v9 offset:12288
  s_waitcnt lgkmcnt(0)
  s_add_u32 s56, s49, 1572864
  s_and_b32 s56, s56, 0xffffff
  s_add_u32 m0, s48, 12288
  s_nop 0
  buffer_load_dwordx4 v2, s[52:55], s56 offen offset:0 nt lds
  buffer_load_dwordx4 v3, s[52:55], s56 offen offset:1024 nt lds
  buffer_load_dwordx4 v4, s[52:55], s56 offen offset:2048 nt lds
  buffer_load_dwordx4 v5, s[52:55], s56 offen offset:3072 nt lds
  s_waitcnt vmcnt(4)
  s_mov_b64 exec, 1
  ds_add_u32 v82, v83
L_sb35:
  ds_read_b64 v[80:81], v82
  s_sub_u32 s82, s82, 1
  s_cbranch_scc1 L_sd35
  s_waitcnt lgkmcnt(0)
  v_readfirstlane_b32 s57, v80
  v_readfirstlane_b32 s83, v81
  s_nop 2
  s_cmp_lt_u32 s57, 140
  s_cbranch_scc1 L_sb35
L_sd35:
  s_mov_b64 exec, -1
  s_nop 1
  v_mfma_f32_16x16x32_bf16 v[56:59], v[192:195], v[40:43], v[56:59]
  v_mfma_f32_16x16x32_bf16 v[56:59], v[196:199], v[44:47], v[56:59]
  v_mfma_f32_16x16x32_bf16 v[56:59], v[200:203], v[48:51], v[56:59]
  v_mfma_f32_16x16x32_bf16 v[56:59], v[204:207], v[52:55], v[56:59]
  v_mfma_f32_16x16x32_bf16 v[60:63], v[208:211], v[40:43], v[60:63]
  v_mfma_f32_16x16x32_bf16 v[60:63], v[212:215], v[44:47], v[60:63]
  v_mfma_f32_16x16x32_bf16 v[60:63], v[216:219], v[48:51], v[60:63]
  v_mfma_f32_16x16x32_bf16 v[60:63], v[220:223], v[52:55], v[60:63]
  ds_read_b128 v[224:227], v6 offset:16384
  ds_read_b128 v[228:231], v7 offset:16384
  ds_read_b128 v[232:235], v8 offset:16384
  ds_read_b128 v[236:239], v9 offset:16384
  s_waitcnt lgkmcnt(0)
  s_add_u32 s56, s49, 2097152
  s_and_b32 s56, s56, 0xffffff
  s_add_u32 m0, s48, 16384
  s_nop 0
  buffer_load_dwordx4 v2, s[52:55], s56 offen offset:0 nt lds
  buffer_load_dwordx4 v3, s[52:55], s56 offen offset:1024 nt lds
  buffer_load_dwordx4 v4, s[52:55], s56 offen offset:2048 nt lds
  buffer_load_dwordx4 v5, s[52:55], s56 offen offset:3072 nt lds
  v_and_b32 v40, v24, v20
  v_and_b32 v41, v25, v20
  v_and_b32 v42, v26, v20
  v_and_b32 v43, v27, v20
  v_and_b32 v44, v28, v20
  v_and_b32 v45, v29, v20
  v_and_b32 v46, v30, v20
  v_and_b32 v47, v31, v20
  v_and_b32 v48, v32, v20
  v_and_b32 v49, v33, v20
  v_and_b32 v50, v34, v20
  v_and_b32 v51, v35, v20
  v_and_b32 v52, v36, v20
  v_and_b32 v53, v37, v20
  v_and_b32 v54, v38, v20
  v_and_b32 v55, v39, v20
  s_waitcnt vmcnt(4)
  s_mov_b64 exec, 1
  ds_add_u32 v82, v83
L_sb36:
  ds_read_b64 v[80:81], v82
  s_sub_u32 s82, s82, 1
  s_cbranch_scc1 L_sd36
  s_waitcnt lgkmcnt(0)
  v_readfirstlane_b32 s57, v80
  v_readfirstlane_b32 s83, v81
  s_nop 2
  s_cmp_lt_u32 s57, 144
  s_cbranch_scc1 L_sb36
L_sd36:
  s_mov_b64 exec, -1
  ds_read_b128 v[240:243], v6 offset:20480
  ds_read_b128 v[244:247], v7 offset:20480
  ds_read_b128 v[248:251], v8 offset:20480
  ds_read_b128 v[252:255], v9 offset:20480
  s_waitcnt lgkmcnt(0)
  s_add_u32 s56, s49, 2621440
  s_and_b32 s56, s56, 0xffffff
  s_add_u32 m0, s48, 20480
  s_nop 0
  buffer_load_dwordx4 v2, s[52:55], s56 offen offset:0 nt lds
  buffer_load_dwordx4 v3, s[52:55], s56 offen offset:1024 nt lds
  buffer_load_dwordx4 v4, s[52:55], s56 offen offset:2048 nt lds
  buffer_load_dwordx4 v5, s[52:55], s56 offen offset:3072 nt lds
  s_waitcnt vmcnt(4)
  s_mov_b64 exec, 1
  ds_add_u32 v82, v83
L_sb37:
  ds_read_b64 v[80:81], v82
  s_sub_u32 s82, s82, 1
  s_cbranch_scc1 L_sd37
  s_waitcnt lgkmcnt(0)
  v_readfirstlane_b32 s57, v80
  v_readfirstlane_b32 s83, v81
  s_nop 2
  s_cmp_lt_u32 s57, 148
  s_cbranch_scc1 L_sb37
L_sd37:
  s_mov_b64 exec, -1
  s_nop 1
  v_mfma_f32_16x16x32_bf16 v[56:59], v[224:227], v[40:43], v[56:59]
  v_mfma_f32_16x16x32_bf16 v[56:59], v[228:231], v[44:47], v[56:59]
  v_mfma_f32_16x16x32_bf16 v[56:59], v[232:235], v[48:51], v[56:59]
  v_mfma_f32_16x16x32_bf16 v[56:59], v[236:239], v[52:55], v[56:59]
  v_mfma_f32_16x16x32_bf16 v[60:63], v[240:243], v[40:43], v[60:63]
  v_mfma_f32_16x16x32_bf16 v[60:63], v[244:247], v[44:47], v[60:63]
  v_mfma_f32_16x16x32_bf16 v[60:63], v[248:251], v[48:51], v[60:63]
  v_mfma_f32_16x16x32_bf16 v[60:63], v[252:255], v[52:55], v[60:63]
  ds_read_b128 v[96:99], v6 offset:24576
  ds_read_b128 v[100:103], v7 offset:24576
  ds_read_b128 v[104:107], v8 offset:24576
  ds_read_b128 v[108:111], v9 offset:24576
  s_waitcnt lgkmcnt(0)
  s_add_u32 s56, s49, 3145728
  s_and_b32 s56, s56, 0xffffff
  s_add_u32 m0, s48, 24576
  s_nop 0
  buffer_load_dwordx4 v2, s[52:55], s56 offen offset:0 nt lds
  buffer_load_dwordx4 v3, s[52:55], s56 offen offset:1024 nt lds
  buffer_load_dwordx4 v4, s[52:55], s56 offen offset:2048 nt lds
  buffer_load_dwordx4 v5, s[52:55], s56 offen offset:3072 nt lds
  v_and_b32 v40, v24, v21
  v_and_b32 v41, v25, v21
  v_and_b32 v42, v26, v21
  v_and_b32 v43, v27, v21
  v_and_b32 v44, v28, v21
  v_and_b32 v45, v29, v21
  v_and_b32 v46, v30, v21
  v_and_b32 v47, v31, v21
  v_and_b32 v48, v32, v21
  v_and_b32 v49, v33, v21
  v_and_b32 v50, v34, v21
  v_and_b32 v51, v35, v21
  v_and_b32 v52, v36, v21
  v_and_b32 v53, v37, v21
  v_and_b32 v54, v38, v21
  v_and_b32 v55, v39, v21
  s_waitcnt vmcnt(4)
  s_mov_b64 exec, 1
  ds_add_u32 v82, v83
L_sb38:
  ds_read_b64 v[80:81], v82
  s_sub_u32 s82, s82, 1
  s_cbranch_scc1 L_sd38
  s_waitcnt lgkmcnt(0)
  v_readfirstlane_b32 s57, v80
  v_readfirstlane_b32 s83, v81
  s_nop 2
  s_cmp_lt_u32 s57, 152
  s_cbranch_scc1 L_sb38
L_sd38:
  s_mov_b64 exec, -1
  ds_read_b128 v[112:115], v6 offset:28672
  ds_read_b128 v[116:119], v7 offset:28672
  ds_read_b128 v[120:123], v8 offset:28672
  ds_read_b128 v[124:127], v9 offset:28672
  s_waitcnt lgkmcnt(0)
  s_add_u32 s56, s49, 3670016
  s_and_b32 s56, s56, 0xffffff
  s_add_u32 m0, s48, 28672
  s_nop 0
  buffer_load_dwordx4 v2, s[52:55], s56 offen offset:0 nt lds
  buffer_load_dwordx4 v3, s[52:55], s56 offen offset:1024 nt lds
  buffer_load_dwordx4 v4, s[52:55], s56 offen offset:2048 nt lds
  buffer_load_dwordx4 v5, s[52:55], s56 offen offset:3072 nt lds
  s_nop 1
  v_mfma_f32_16x16x32_bf16 v[56:59], v[96:99], v[40:43], v[56:59]
  v_mfma_f32_16x16x32_bf16 v[56:59], v[100:103], v[44:47], v[56:59]
  v_mfma_f32_16x16x32_bf16 v[56:59], v[104:107], v[48:51], v[56:59]
  v_mfma_f32_16x16x32_bf16 v[56:59], v[108:111], v[52:55], v[56:59]
  v_mfma_f32_16x16x32_bf16 v[60:63], v[112:115], v[40:43], v[60:63]
  v_mfma_f32_16x16x32_bf16 v[60:63], v[116:119], v[44:47], v[60:63]
  v_mfma_f32_16x16x32_bf16 v[60:63], v[120:123], v[48:51], v[60:63]
  v_mfma_f32_16x16x32_bf16 v[60:63], v[124:127], v[52:55], v[60:63]
  s_nop 5
  v_cvt_pk_bf16_f32 v84, v56, v57
  v_cvt_pk_bf16_f32 v85, v58, v59
  v_cvt_pk_bf16_f32 v86, v60, v61
  v_cvt_pk_bf16_f32 v87, v62, v63
  v_lshlrev_b32 v88, 16, v84
  v_and_b32 v89, 0xffff0000, v84
  v_lshlrev_b32 v90, 16, v85
  v_and_b32 v91, 0xffff0000, v85
  v_lshlrev_b32 v92, 16, v86
  v_and_b32 v93, 0xffff0000, v86
  v_lshlrev_b32 v94, 16, v87
  v_and_b32 v95, 0xffff0000, v87
  v_mul_f32 v88, s58, v88
  v_mul_f32 v89, s58, v89
  v_mul_f32 v90, s58, v90
  v_mul_f32 v91, s58, v91
  v_mul_f32 v92, s58, v92
  v_mul_f32 v93, s58, v93
  v_mul_f32 v94, s58, v94
  v_mul_f32 v95, s58, v95
  v_cvt_pk_bf16_f32 v76, v88, v89
  v_cvt_pk_bf16_f32 v77, v90, v91
  v_cvt_pk_bf16_f32 v78, v92, v93
  v_cvt_pk_bf16_f32 v79, v94, v95
  v_lshlrev_b32 v176, 16, v64
  v_and_b32 v177, 0xffff0000, v64
  v_lshlrev_b32 v178, 16, v65
  v_and_b32 v179, 0xffff0000, v65
  v_lshlrev_b32 v180, 16, v66
  v_and_b32 v181, 0xffff0000, v66
  v_lshlrev_b32 v182, 16, v67
  v_and_b32 v183, 0xffff0000, v67
  v_lshlrev_b32 v184, 16, v68
  v_and_b32 v185, 0xffff0000, v68
  v_lshlrev_b32 v186, 16, v69
  v_and_b32 v187, 0xffff0000, v69
  v_lshlrev_b32 v188, 16, v70
  v_and_b32 v189, 0xffff0000, v70
  v_lshlrev_b32 v190, 16, v71
  v_and_b32 v191, 0xffff0000, v71
  v_lshlrev_b32 v192, 16, v72
  v_and_b32 v193, 0xffff0000, v72
  v_lshlrev_b32 v194, 16, v73
  v_and_b32 v195, 0xffff0000, v73
  v_lshlrev_b32 v196, 16, v74
  v_and_b32 v197, 0xffff0000, v74
  v_lshlrev_b32 v198, 16, v75
  v_and_b32 v199, 0xffff0000, v75
  v_lshlrev_b32 v200, 16, v76
  v_and_b32 v201, 0xffff0000, v76
  v_lshlrev_b32 v202, 16, v77
  v_and_b32 v203, 0xffff0000, v77
  v_lshlrev_b32 v204, 16, v78
  v_and_b32 v205, 0xffff0000, v78
  v_lshlrev_b32 v206, 16, v79
  v_and_b32 v207, 0xffff0000, v79
  s_waitcnt vmcnt(4)
  s_mov_b64 exec, 1
  ds_add_u32 v82, v83
L_sb39:
  ds_read_b64 v[80:81], v82
  s_sub_u32 s82, s82, 1
  s_cbranch_scc1 L_sd39
  s_waitcnt lgkmcnt(0)
  v_readfirstlane_b32 s57, v80
  v_readfirstlane_b32 s83, v81
  s_nop 2
  s_cmp_lt_u32 s57, 156
  s_cbranch_scc1 L_sb39
L_sd39:
  s_mov_b64 exec, -1
  ds_read_b64_tr_b16 v[96:97], v10 offset:0
  ds_read_b64_tr_b16 v[100:101], v11 offset:0
  ds_read_b64_tr_b16 v[104:105], v12 offset:0
  ds_read_b64_tr_b16 v[108:109], v13 offset:0
  ds_read_b64_tr_b16 v[112:113], v14 offset:0
  ds_read_b64_tr_b16 v[116:117], v15 offset:0
  ds_read_b64_tr_b16 v[120:121], v16 offset:0
  ds_read_b64_tr_b16 v[124:125], v17 offset:0
  s_waitcnt lgkmcnt(0)
  s_add_u32 s56, s49, 4194304
  s_and_b32 s56, s56, 0xffffff
  s_add_u32 m0, s48, 0
  s_nop 0
  buffer_load_dwordx4 v2, s[52:55], s56 offen offset:0 nt lds
  buffer_load_dwordx4 v3, s[52:55], s56 offen offset:1024 nt lds
  buffer_load_dwordx4 v4, s[52:55], s56 offen offset:2048 nt lds
  buffer_load_dwordx4 v5, s[52:55], s56 offen offset:3072 nt lds
  v_max_f32 v24, v176, v177
  v_max_f32 v25, v178, v179
  v_max3_f32 v24, v24, v180, v181
  v_max3_f32 v25, v25, v182, v183
  v_max3_f32 v24, v24, v184, v185
  v_max3_f32 v25, v25, v186, v187
  v_max3_f32 v24, v24, v188, v189
  v_max3_f32 v25, v25, v190, v191
  v_max3_f32 v24, v24, v192, v193
  v_max3_f32 v25, v25, v194, v195
  v_max3_f32 v24, v24, v196, v197
  v_max3_f32 v25, v25, v198, v199
  v_max3_f32 v24, v24, v200, v201
  v_max3_f32 v25, v25, v202, v203
  v_max3_f32 v24, v24, v204, v205
  v_max3_f32 v25, v25, v206, v207
  v_max_f32 v24, v24, v25
  s_nop 1
  v_max_f32_dpp v24, v24, v24 row_ror:4 row_mask:0xf bank_mask:0xf
  s_nop 1
  v_max_f32_dpp v24, v24, v24 row_ror:8 row_mask:0xf bank_mask:0xf
  v_mov_b32 v25, v24
  s_nop 1
  v_permlane16_swap_b32 v24, v25
  s_nop 1
  v_max_f32 v24, v24, v25
  v_mov_b32 v25, v24
  s_nop 1
  v_permlane32_swap_b32 v24, v25
  s_nop 1
  v_max_f32 v24, v24, v25
  v_sub_f32 v176, v176, v24
  v_sub_f32 v177, v177, v24
  v_sub_f32 v178, v178, v24
  v_sub_f32 v179, v179, v24
  v_sub_f32 v180, v180, v24
  v_sub_f32 v181, v181, v24
  v_sub_f32 v182, v182, v24
  v_sub_f32 v183, v183, v24
  v_sub_f32 v184, v184, v24
  v_sub_f32 v185, v185, v24
  v_sub_f32 v186, v186, v24
  v_sub_f32 v187, v187, v24
  v_sub_f32 v188, v188, v24
  v_sub_f32 v189, v189, v24
  v_sub_f32 v190, v190, v24
  v_sub_f32 v191, v191, v24
  v_sub_f32 v192, v192, v24
  v_sub_f32 v193, v193, v24
  v_sub_f32 v194, v194, v24
  v_sub_f32 v195, v195, v24
  v_sub_f32 v196, v196, v24
  v_sub_f32 v197, v197, v24
  v_sub_f32 v198, v198, v24
  v_sub_f32 v199, v199, v24
  v_sub_f32 v200, v200, v24
  v_sub_f32 v201, v201, v24
  v_sub_f32 v202, v202, v24
  v_sub_f32 v203, v203, v24
  v_sub_f32 v204, v204, v24
  v_sub_f32 v205, v205, v24
  v_sub_f32 v206, v206, v24
  v_sub_f32 v207, v207, v24
  v_mul_f32 v176, s59, v176
  v_mul_f32 v177, s59, v177
  v_mul_f32 v178, s59, v178
  v_mul_f32 v179, s59, v179
  v_mul_f32 v180, s59, v180
  v_mul_f32 v181, s59, v181
  v_mul_f32 v182, s59, v182
  v_mul_f32 v183, s59, v183
  v_mul_f32 v184, s59, v184
  v_mul_f32 v185, s59, v185
  v_mul_f32 v186, s59, v186
  v_mul_f32 v187, s59, v187
  v_mul_f32 v188, s59, v188
  v_mul_f32 v189, s59, v189
  v_mul_f32 v190, s59, v190
  v_mul_f32 v191, s59, v191
  v_mul_f32 v192, s59, v192
  v_mul_f32 v193, s59, v193
  v_mul_f32 v194, s59, v194
  v_mul_f32 v195, s59, v195
  v_mul_f32 v196, s59, v196
  v_mul_f32 v197, s59, v197
  v_mul_f32 v198, s59, v198
  v_mul_f32 v199, s59, v199
  v_mul_f32 v200, s59, v200
  v_mul_f32 v201, s59, v201
  v_mul_f32 v202, s59, v202
  v_mul_f32 v203, s59, v203
  v_mul_f32 v204, s59, v204
  v_mul_f32 v205, s59, v205
  v_mul_f32 v206, s59, v206
  v_mul_f32 v207, s59, v207
  v_exp_f32 v176, v176
  v_exp_f32 v177, v177
  v_exp_f32 v178, v178
  v_exp_f32 v179, v179
  v_exp_f32 v180, v180
  v_exp_f32 v181, v181
  v_exp_f32 v182, v182
  v_exp_f32 v183, v183
  v_exp_f32 v184, v184
  v_exp_f32 v185, v185
  v_exp_f32 v186, v186
  v_exp_f32 v187, v187
  v_exp_f32 v188, v188
  v_exp_f32 v189, v189
  v_exp_f32 v190, v190
  v_exp_f32 v191, v191
  v_exp_f32 v192, v192
  v_exp_f32 v193, v193
  v_exp_f32 v194, v194
  v_exp_f32 v195, v195
  v_exp_f32 v196, v196
  v_exp_f32 v197, v197
  v_exp_f32 v198, v198
  v_exp_f32 v199, v199
  v_exp_f32 v200, v200
  v_exp_f32 v201, v201
  v_exp_f32 v202, v202
  v_exp_f32 v203, v203
  v_exp_f32 v204, v204
  v_exp_f32 v205, v205
  v_exp_f32 v206, v206
  v_exp_f32 v207, v207
  s_waitcnt vmcnt(4)
  s_mov_b64 exec, 1
  ds_add_u32 v82, v83
L_sb40:
  ds_read_b64 v[80:81], v82
  s_sub_u32 s82, s82, 1
  s_cbranch_scc1 L_sd40
  s_waitcnt lgkmcnt(0)
  v_readfirstlane_b32 s57, v80
  v_readfirstlane_b32 s83, v81
  s_nop 2
  s_cmp_lt_u32 s57, 160
  s_cbranch_scc1 L_sb40
L_sd40:
  s_mov_b64 exec, -1
  ds_read_b64_tr_b16 v[98:99], v10 offset:4096
  ds_read_b64_tr_b16 v[102:103], v11 offset:4096
  ds_read_b64_tr_b16 v[106:107], v12 offset:4096
  ds_read_b64_tr_b16 v[110:111], v13 offset:4096
  ds_read_b64_tr_b16 v[114:115], v14 offset:4096
  ds_read_b64_tr_b16 v[118:119], v15 offset:4096
  ds_read_b64_tr_b16 v[122:123], v16 offset:4096
  ds_read_b64_tr_b16 v[126:127], v17 offset:4096
  s_waitcnt lgkmcnt(0)
  s_add_u32 s56, s49, 4718592
  s_and_b32 s56, s56, 0xffffff
  s_add_u32 m0, s48, 4096
  s_nop 0
  buffer_load_dwordx4 v2, s[52:55], s56 offen offset:0 nt lds
  buffer_load_dwordx4 v3, s[52:55], s56 offen offset:1024 nt lds
  buffer_load_dwordx4 v4, s[52:55], s56 offen offset:2048 nt lds
  buffer_load_dwordx4 v5, s[52:55], s56 offen offset:3072 nt lds
  v_cvt_pk_bf16_f32 v64, v176, v177
  v_cvt_pk_bf16_f32 v65, v178, v179
  v_cvt_pk_bf16_f32 v66, v180, v181
  v_cvt_pk_bf16_f32 v67, v182, v183
  v_cvt_pk_bf16_f32 v68, v184, v185
  v_cvt_pk_bf16_f32 v69, v186, v187
  v_cvt_pk_bf16_f32 v70, v188, v189
  v_cvt_pk_bf16_f32 v71, v190, v191
  v_cvt_pk_bf16_f32 v72, v192, v193
  v_cvt_pk_bf16_f32 v73, v194, v195
  v_cvt_pk_bf16_f32 v74, v196, v197
  v_cvt_pk_bf16_f32 v75, v198, v199
  v_cvt_pk_bf16_f32 v76, v200, v201
  v_cvt_pk_bf16_f32 v77, v202, v203
  v_cvt_pk_bf16_f32 v78, v204, v205
  v_cvt_pk_bf16_f32 v79, v206, v207
  v_add_f32 v176, v176, v192
  v_add_f32 v177, v177, v193
  v_add_f32 v178, v178, v194
  v_add_f32 v179, v179, v195
  v_add_f32 v180, v180, v196
  v_add_f32 v181, v181, v197
  v_add_f32 v182, v182, v198
  v_add_f32 v183, v183, v199
  v_add_f32 v184, v184, v200
  v_add_f32 v185, v185, v201
  v_add_f32 v186, v186, v202
  v_add_f32 v187, v187, v203
  v_add_f32 v188, v188, v204
  v_add_f32 v189, v189, v205
  v_add_f32 v190, v190, v206
  v_add_f32 v191, v191, v207
  v_add_f32 v176, v176, v184
  v_add_f32 v177, v177, v185
  v_add_f32 v178, v178, v186
  v_add_f32 v179, v179, v187
  v_add_f32 v180, v180, v188
  v_add_f32 v181, v181, v189
  v_add_f32 v182, v182, v190
  v_add_f32 v183, v183, v191
  v_add_f32 v176, v176, v180
  v_add_f32 v177, v177, v181
  v_add_f32 v178, v178, v182
  v_add_f32 v179, v179, v183
  v_add_f32 v176, v176, v178
  v_add_f32 v177, v177, v179
  v_add_f32 v176, v176, v177
  v_mov_b32 v25, v176
  s_nop 1
  v_add_f32_dpp v25, v25, v25 row_ror:4 row_mask:0xf bank_mask:0xf
  s_nop 1
  v_add_f32_dpp v25, v25, v25 row_ror:8 row_mask:0xf bank_mask:0xf
  v_mov_b32 v26, v25
  s_nop 1
  v_permlane16_swap_b32 v25, v26
  s_nop 1
  v_add_f32 v25, v25, v26
  v_mov_b32 v26, v25
  s_nop 1
  v_permlane32_swap_b32 v25, v26
  s_nop 1
  v_add_f32 v25, v25, v26
  v_mov_b32 v22, v24
  s_lshl_b32 s57, s3, 5
  s_add_u32 s57, s57, 161792
  v_lshl_add_u32 v26, v1, 2, s57
  s_lshl_b32 s57, s3, 2
  s_add_u32 s57, s57, 161920
  v_mov_b32 v27, s57
  v_mov_b32 v28, 1
  s_mov_b64 exec, 15
  ds_write_b32 v26, v24
  ds_write_b32 v26, v25 offset:16
  s_waitcnt lgkmcnt(0)
  s_mov_b64 exec, 1
  ds_write_b32 v27, v28
  s_mov_b64 exec, -1
  v_and_b32 v128, v64, v18
  v_and_b32 v129, v65, v18
  v_and_b32 v130, v66, v18
  v_and_b32 v131, v67, v18
  s_nop 1
  s_waitcnt vmcnt(4)
  s_mov_b64 exec, 1
  ds_add_u32 v82, v83
L_sb41:
  ds_read_b64 v[80:81], v82
  s_sub_u32 s82, s82, 1
  s_cbranch_scc1 L_sd41
  s_waitcnt lgkmcnt(0)
  v_readfirstlane_b32 s57, v80
  v_readfirstlane_b32 s83, v81
  s_nop 2
  s_cmp_lt_u32 s57, 164
  s_cbranch_scc1 L_sb41
L_sd41:
  s_mov_b64 exec, -1
  v_mfma_f32_16x16x32_bf16 v[144:147], v[96:99], v[128:131], 0
  v_mfma_f32_16x16x32_bf16 v[148:151], v[100:103], v[128:131], 0
  v_mfma_f32_16x16x32_bf16 v[152:155], v[104:107], v[128:131], 0
  v_mfma_f32_16x16x32_bf16 v[156:159], v[108:111], v[128:131], 0
  v_mfma_f32_16x16x32_bf16 v[160:163], v[112:115], v[128:131], 0
  v_mfma_f32_16x16x32_bf16 v[164:167], v[116:119], v[128:131], 0
  v_mfma_f32_16x16x32_bf16 v[168:171], v[120:123], v[128:131], 0
  v_mfma_f32_16x16x32_bf16 v[172:175], v[124:127], v[128:131], 0
  v_and_b32 v132, v64, v19
  v_and_b32 v133, v65, v19
  v_and_b32 v134, v66, v19
  v_and_b32 v135, v67, v19
  ds_read_b64_tr_b16 v[96:97], v10 offset:8192
  ds_read_b64_tr_b16 v[100:101], v11 offset:8192
  ds_read_b64_tr_b16 v[104:105], v12 offset:8192
  ds_read_b64_tr_b16 v[108:109], v13 offset:8192
  ds_read_b64_tr_b16 v[112:113], v14 offset:8192
  ds_read_b64_tr_b16 v[116:117], v15 offset:8192
  ds_read_b64_tr_b16 v[120:121], v16 offset:8192
  ds_read_b64_tr_b16 v[124:125], v17 offset:8192
  s_waitcnt lgkmcnt(0)
  s_add_u32 s56, s49, 5242880
  s_and_b32 s56, s56, 0xffffff
  s_add_u32 m0, s48, 8192
  s_nop 0
  buffer_load_dwordx4 v2, s[52:55], s56 offen offset:0 nt lds
  buffer_load_dwordx4 v3, s[52:55], s56 offen offset:1024 nt lds
  buffer_load_dwordx4 v4, s[52:55], s56 offen offset:2048 nt lds
  buffer_load_dwordx4 v5, s[52:55], s56 offen offset:3072 nt lds
  s_waitcnt vmcnt(4)
  s_mov_b64 exec, 1
  ds_add_u32 v82, v83
L_sb42:
  ds_read_b64 v[80:81], v82
  s_sub_u32 s82, s82, 1
  s_cbranch_scc1 L_sd42
  s_waitcnt lgkmcnt(0)
  v_readfirstlane_b32 s57, v80
  v_readfirstlane_b32 s83, v81
  s_nop 2
  s_cmp_lt_u32 s57, 168
  s_cbranch_scc1 L_sb42
L_sd42:
  s_mov_b64 exec, -1
  ds_read_b64_tr_b16 v[98:99], v10 offset:12288
  ds_read_b64_tr_b16 v[102:103], v11 offset:12288
  ds_read_b64_tr_b16 v[106:107], v12 offset:12288
  ds_read_b64_tr_b16 v[110:111], v13 offset:12288
  ds_read_b64_tr_b16 v[114:115], v14 offset:12288
  ds_read_b64_tr_b16 v[118:119], v15 offset:12288
  ds_read_b64_tr_b16 v[122:123], v16 offset:12288
  ds_read_b64_tr_b16 v[126:127], v17 offset:12288
  s_waitcnt lgkmcnt(0)
  s_add_u32 s56, s49, 5767168
  s_and_b32 s56, s56, 0xffffff
  s_add_u32 m0, s48, 12288
  s_nop 0
  buffer_load_dwordx4 v2, s[52:55], s56 offen offset:0 nt lds
  buffer_load_dwordx4 v3, s[52:55], s56 offen offset:1024 nt lds
  buffer_load_dwordx4 v4, s[52:55], s56 offen offset:2048 nt lds
  buffer_load_dwordx4 v5, s[52:55], s56 offen offset:3072 nt lds
  s_waitcnt vmcnt(4)
  s_mov_b64 exec, 1
  ds_add_u32 v82, v83
L_sb43:
  ds_read_b64 v[80:81], v82
  s_sub_u32 s82, s82, 1
  s_cbranch_scc1 L_sd43
  s_waitcnt lgkmcnt(0)
  v_readfirstlane_b32 s57, v80
  v_readfirstlane_b32 s83, v81
  s_nop 2
  s_cmp_lt_u32 s57, 172
  s_cbranch_scc1 L_sb43
L_sd43:
  s_mov_b64 exec, -1
  v_mfma_f32_16x16x32_bf16 v[144:147], v[96:99], v[132:135], v[144:147]
  v_mfma_f32_16x16x32_bf16 v[148:151], v[100:103], v[132:135], v[148:151]
  v_mfma_f32_16x16x32_bf16 v[152:155], v[104:107], v[132:135], v[152:155]
  v_mfma_f32_16x16x32_bf16 v[156:159], v[108:111], v[132:135], v[156:159]
  v_mfma_f32_16x16x32_bf16 v[160:163], v[112:115], v[132:135], v[160:163]
  v_mfma_f32_16x16x32_bf16 v[164:167], v[116:119], v[132:135], v[164:167]
  v_mfma_f32_16x16x32_bf16 v[168:171], v[120:123], v[132:135], v[168:171]
  v_mfma_f32_16x16x32_bf16 v[172:175], v[124:127], v[132:135], v[172:175]
  v_and_b32 v128, v64, v20
  v_and_b32 v129, v65, v20
  v_and_b32 v130, v66, v20
  v_and_b32 v131, v67, v20
  ds_read_b64_tr_b16 v[96:97], v10 offset:16384
  ds_read_b64_tr_b16 v[100:101], v11 offset:16384
  ds_read_b64_tr_b16 v[104:105], v12 offset:16384
  ds_read_b64_tr_b16 v[108:109], v13 offset:16384
  ds_read_b64_tr_b16 v[112:113], v14 offset:16384
  ds_read_b64_tr_b16 v[116:117], v15 offset:16384
  ds_read_b64_tr_b16 v[120:121], v16 offset:16384
  ds_read_b64_tr_b16 v[124:125], v17 offset:16384
  s_waitcnt lgkmcnt(0)
  s_add_u32 s56, s49, 6291456
  s_and_b32 s56, s56, 0xffffff
  s_add_u32 m0, s48, 16384
  s_nop 0
  buffer_load_dwordx4 v2, s[52:55], s56 offen offset:0 nt lds
  buffer_load_dwordx4 v3, s[52:55], s56 offen offset:1024 nt lds
  buffer_load_dwordx4 v4, s[52:55], s56 offen offset:2048 nt lds
  buffer_load_dwordx4 v5, s[52:55], s56 offen offset:3072 nt lds
  s_waitcnt vmcnt(4)
  s_mov_b64 exec, 1
  ds_add_u32 v82, v83
L_sb44:
  ds_read_b64 v[80:81], v82
  s_sub_u32 s82, s82, 1
  s_cbranch_scc1 L_sd44
  s_waitcnt lgkmcnt(0)
  v_readfirstlane_b32 s57, v80
  v_readfirstlane_b32 s83, v81
  s_nop 2
  s_cmp_lt_u32 s57, 176
  s_cbranch_scc1 L_sb44
L_sd44:
  s_mov_b64 exec, -1
  ds_read_b64_tr_b16 v[98:99], v10 offset:20480
  ds_read_b64_tr_b16 v[102:103], v11 offset:20480
  ds_read_b64_tr_b16 v[106:107], v12 offset:20480
  ds_read_b64_tr_b16 v[110:111], v13 offset:20480
  ds_read_b64_tr_b16 v[114:115], v14 offset:20480
  ds_read_b64_tr_b16 v[118:119], v15 offset:20480
  ds_read_b64_tr_b16 v[122:123], v16 offset:20480
  ds_read_b64_tr_b16 v[126:127], v17 offset:20480
  s_waitcnt lgkmcnt(0)
  s_add_u32 s56, s49, 6815744
  s_and_b32 s56, s56, 0xffffff
  s_add_u32 m0, s48, 20480
  s_nop 0
  buffer_load_dwordx4 v2, s[52:55], s56 offen offset:0 nt lds
  buffer_load_dwordx4 v3, s[52:55], s56 offen offset:1024 nt lds
  buffer_load_dwordx4 v4, s[52:55], s56 offen offset:2048 nt lds
  buffer_load_dwordx4 v5, s[52:55], s56 offen offset:3072 nt lds
  s_waitcnt vmcnt(4)
  s_mov_b64 exec, 1
  ds_add_u32 v82, v83
L_sb45:
  ds_read_b64 v[80:81], v82
  s_sub_u32 s82, s82, 1
  s_cbranch_scc1 L_sd45
  s_waitcnt lgkmcnt(0)
  v_readfirstlane_b32 s57, v80
  v_readfirstlane_b32 s83, v81
  s_nop 2
  s_cmp_lt_u32 s57, 180
  s_cbranch_scc1 L_sb45
L_sd45:
  s_mov_b64 exec, -1
  v_mfma_f32_16x16x32_bf16 v[144:147], v[96:99], v[128:131], v[144:147]
  v_mfma_f32_16x16x32_bf16 v[148:151], v[100:103], v[128:131], v[148:151]
  v_mfma_f32_16x16x32_bf16 v[152:155], v[104:107], v[128:131], v[152:155]
  v_mfma_f32_16x16x32_bf16 v[156:159], v[108:111], v[128:131], v[156:159]
  v_mfma_f32_16x16x32_bf16 v[160:163], v[112:115], v[128:131], v[160:163]
  v_mfma_f32_16x16x32_bf16 v[164:167], v[116:119], v[128:131], v[164:167]
  v_mfma_f32_16x16x32_bf16 v[168:171], v[120:123], v[128:131], v[168:171]
  v_mfma_f32_16x16x32_bf16 v[172:175], v[124:127], v[128:131], v[172:175]
  v_and_b32 v132, v64, v21
  v_and_b32 v133, v65, v21
  v_and_b32 v134, v66, v21
  v_and_b32 v135, v67, v21
  ds_read_b64_tr_b16 v[96:97], v10 offset:24576
  ds_read_b64_tr_b16 v[100:101], v11 offset:24576
  ds_read_b64_tr_b16 v[104:105], v12 offset:24576
  ds_read_b64_tr_b16 v[108:109], v13 offset:24576
  ds_read_b64_tr_b16 v[112:113], v14 offset:24576
  ds_read_b64_tr_b16 v[116:117], v15 offset:24576
  ds_read_b64_tr_b16 v[120:121], v16 offset:24576
  ds_read_b64_tr_b16 v[124:125], v17 offset:24576
  s_waitcnt lgkmcnt(0)
  s_add_u32 s56, s49, 7340032
  s_and_b32 s56, s56, 0xffffff
  s_add_u32 m0, s48, 24576
  s_nop 0
  buffer_load_dwordx4 v2, s[52:55], s56 offen offset:0 nt lds
  buffer_load_dwordx4 v3, s[52:55], s56 offen offset:1024 nt lds
  buffer_load_dwordx4 v4, s[52:55], s56 offen offset:2048 nt lds
  buffer_load_dwordx4 v5, s[52:55], s56 offen offset:3072 nt lds
  s_waitcnt vmcnt(4)
  s_mov_b64 exec, 1
  ds_add_u32 v82, v83
L_sb46:
  ds_read_b64 v[80:81], v82
  s_sub_u32 s82, s82, 1
  s_cbranch_scc1 L_sd46
  s_waitcnt lgkmcnt(0)
  v_readfirstlane_b32 s57, v80
  v_readfirstlane_b32 s83, v81
  s_nop 2
  s_cmp_lt_u32 s57, 184
  s_cbranch_scc1 L_sb46
L_sd46:
  s_mov_b64 exec, -1
  ds_read_b64_tr_b16 v[98:99], v10 offset:28672
  ds_read_b64_tr_b16 v[102:103], v11 offset:28672
  ds_read_b64_tr_b16 v[106:107], v12 offset:28672
  ds_read_b64_tr_b16 v[110:111], v13 offset:28672
  ds_read_b64_tr_b16 v[114:115], v14 offset:28672
  ds_read_b64_tr_b16 v[118:119], v15 offset:28672
  ds_read_b64_tr_b16 v[122:123], v16 offset:28672
  ds_read_b64_tr_b16 v[126:127], v17 offset:28672
  s_waitcnt lgkmcnt(0)
  s_add_u32 s56, s49, 7864320
  s_and_b32 s56, s56, 0xffffff
  s_add_u32 m0, s48, 28672
  s_nop 0
  buffer_load_dwordx4 v2, s[52:55], s56 offen offset:0 nt lds
  buffer_load_dwordx4 v3, s[52:55], s56 offen offset:1024 nt lds
  buffer_load_dwordx4 v4, s[52:55], s56 offen offset:2048 nt lds
  buffer_load_dwordx4 v5, s[52:55], s56 offen offset:3072 nt lds
  s_waitcnt vmcnt(4)
  s_mov_b64 exec, 1
  ds_add_u32 v82, v83
L_sb47:
  ds_read_b64 v[80:81], v82
  s_sub_u32 s82, s82, 1
  s_cbranch_scc1 L_sd47
  s_waitcnt lgkmcnt(0)
  v_readfirstlane_b32 s57, v80
  v_readfirstlane_b32 s83, v81
  s_nop 2
  s_cmp_lt_u32 s57, 188
  s_cbranch_scc1 L_sb47
L_sd47:
  s_mov_b64 exec, -1
  v_mfma_f32_16x16x32_bf16 v[144:147], v[96:99], v[132:135], v[144:147]
  v_mfma_f32_16x16x32_bf16 v[148:151], v[100:103], v[132:135], v[148:151]
  v_mfma_f32_16x16x32_bf16 v[152:155], v[104:107], v[132:135], v[152:155]
  v_mfma_f32_16x16x32_bf16 v[156:159], v[108:111], v[132:135], v[156:159]
  v_mfma_f32_16x16x32_bf16 v[160:163], v[112:115], v[132:135], v[160:163]
  v_mfma_f32_16x16x32_bf16 v[164:167], v[116:119], v[132:135], v[164:167]
  v_mfma_f32_16x16x32_bf16 v[168:171], v[120:123], v[132:135], v[168:171]
  v_mfma_f32_16x16x32_bf16 v[172:175], v[124:127], v[132:135], v[172:175]
  v_and_b32 v128, v68, v18
  v_and_b32 v129, v69, v18
  v_and_b32 v130, v70, v18
  v_and_b32 v131, v71, v18
  ds_read_b64_tr_b16 v[96:97], v10 offset:0
  ds_read_b64_tr_b16 v[100:101], v11 offset:0
  ds_read_b64_tr_b16 v[104:105], v12 offset:0
  ds_read_b64_tr_b16 v[108:109], v13 offset:0
  ds_read_b64_tr_b16 v[112:113], v14 offset:0
  ds_read_b64_tr_b16 v[116:117], v15 offset:0
  ds_read_b64_tr_b16 v[120:121], v16 offset:0
  ds_read_b64_tr_b16 v[124:125], v17 offset:0
  s_waitcnt lgkmcnt(0)
  s_add_u32 s56, s49, 8388608
  s_and_b32 s56, s56, 0xffffff
  s_add_u32 m0, s48, 0
  s_nop 0
  buffer_load_dwordx4 v2, s[52:55], s56 offen offset:0 nt lds
  buffer_load_dwordx4 v3, s[52:55], s56 offen offset:1024 nt lds
  buffer_load_dwordx4 v4, s[52:55], s56 offen offset:2048 nt lds
  buffer_load_dwordx4 v5, s[52:55], s56 offen offset:3072 nt lds
  s_waitcnt vmcnt(4)
  s_mov_b64 exec, 1
  ds_add_u32 v82, v83
L_sb48:
  ds_read_b64 v[80:81], v82
  s_sub_u32 s82, s82, 1
  s_cbranch_scc1 L_sd48
  s_waitcnt lgkmcnt(0)
  v_readfirstlane_b32 s57, v80
  v_readfirstlane_b32 s83, v81
  s_nop 2
  s_cmp_lt_u32 s57, 192
  s_cbranch_scc1 L_sb48
L_sd48:
  s_mov_b64 exec, -1
  ds_read_b64_tr_b16 v[98:99], v10 offset:4096
  ds_read_b64_tr_b16 v[102:103], v11 offset:4096
  ds_read_b64_tr_b16 v[106:107], v12 offset:4096
  ds_read_b64_tr_b16 v[110:111], v13 offset:4096
  ds_read_b64_tr_b16 v[114:115], v14 offset:4096
  ds_read_b64_tr_b16 v[118:119], v15 offset:4096
  ds_read_b64_tr_b16 v[122:123], v16 offset:4096
  ds_read_b64_tr_b16 v[126:127], v17 offset:4096
  s_waitcnt lgkmcnt(0)
  s_add_u32 s56, s49, 8912896
  s_and_b32 s56, s56, 0xffffff
  s_add_u32 m0, s48, 4096
  s_nop 0
  buffer_load_dwordx4 v2, s[52:55], s56 offen offset:0 nt lds
  buffer_load_dwordx4 v3, s[52:55], s56 offen offset:1024 nt lds
  buffer_load_dwordx4 v4, s[52:55], s56 offen offset:2048 nt lds
  buffer_load_dwordx4 v5, s[52:55], s56 offen offset:3072 nt lds
  s_waitcnt vmcnt(4)
  s_mov_b64 exec, 1
  ds_add_u32 v82, v83
L_sb49:
  ds_read_b64 v[80:81], v82
  s_sub_u32 s82, s82, 1
  s_cbranch_scc1 L_sd49
  s_waitcnt lgkmcnt(0)
  v_readfirstlane_b32 s57, v80
  v_readfirstlane_b32 s83, v81
  s_nop 2
  s_cmp_lt_u32 s57, 196
  s_cbranch_scc1 L_sb49
L_sd49:
  s_mov_b64 exec, -1
  v_mfma_f32_16x16x32_bf16 v[144:147], v[96:99], v[128:131], v[144:147]
  v_mfma_f32_16x16x32_bf16 v[148:151], v[100:103], v[128:131], v[148:151]
  v_mfma_f32_16x16x32_bf16 v[152:155], v[104:107], v[128:131], v[152:155]
  v_mfma_f32_16x16x32_bf16 v[156:159], v[108:111], v[128:131], v[156:159]
  v_mfma_f32_16x16x32_bf16 v[160:163], v[112:115], v[128:131], v[160:163]
  v_mfma_f32_16x16x32_bf16 v[164:167], v[116:119], v[128:131], v[164:167]
  v_mfma_f32_16x16x32_bf16 v[168:171], v[120:123], v[128:131], v[168:171]
  v_mfma_f32_16x16x32_bf16 v[172:175], v[124:127], v[128:131], v[172:175]
  v_and_b32 v132, v68, v19
  v_and_b32 v133, v69, v19
  v_and_b32 v134, v70, v19
  v_and_b32 v135, v71, v19
  ds_read_b64_tr_b16 v[96:97], v10 offset:8192
  ds_read_b64_tr_b16 v[100:101], v11 offset:8192
  ds_read_b64_tr_b16 v[104:105], v12 offset:8192
  ds_read_b64_tr_b16 v[108:109], v13 offset:8192
  ds_read_b64_tr_b16 v[112:113], v14 offset:8192
  ds_read_b64_tr_b16 v[116:117], v15 offset:8192
  ds_read_b64_tr_b16 v[120:121], v16 offset:8192
  ds_read_b64_tr_b16 v[124:125], v17 offset:8192
  s_waitcnt lgkmcnt(0)
  s_add_u32 s56, s49, 9437184
  s_and_b32 s56, s56, 0xffffff
  s_add_u32 m0, s48, 8192
  s_nop 0
  buffer_load_dwordx4 v2, s[52:55], s56 offen offset:0 nt lds
  buffer_load_dwordx4 v3, s[52:55], s56 offen offset:1024 nt lds
  buffer_load_dwordx4 v4, s[52:55], s56 offen offset:2048 nt lds
  buffer_load_dwordx4 v5, s[52:55], s56 offen offset:3072 nt lds
  s_waitcnt vmcnt(4)
  s_mov_b64 exec, 1
  ds_add_u32 v82, v83
L_sb50:
  ds_read_b64 v[80:81], v82
  s_sub_u32 s82, s82, 1
  s_cbranch_scc1 L_sd50
  s_waitcnt lgkmcnt(0)
  v_readfirstlane_b32 s57, v80
  v_readfirstlane_b32 s83, v81
  s_nop 2
  s_cmp_lt_u32 s57, 200
  s_cbranch_scc1 L_sb50
L_sd50:
  s_mov_b64 exec, -1
  ds_read_b64_tr_b16 v[98:99], v10 offset:12288
  ds_read_b64_tr_b16 v[102:103], v11 offset:12288
  ds_read_b64_tr_b16 v[106:107], v12 offset:12288
  ds_read_b64_tr_b16 v[110:111], v13 offset:12288
  ds_read_b64_tr_b16 v[114:115], v14 offset:12288
  ds_read_b64_tr_b16 v[118:119], v15 offset:12288
  ds_read_b64_tr_b16 v[122:123], v16 offset:12288
  ds_read_b64_tr_b16 v[126:127], v17 offset:12288
  s_waitcnt lgkmcnt(0)
  s_add_u32 s56, s49, 9961472
  s_and_b32 s56, s56, 0xffffff
  s_add_u32 m0, s48, 12288
  s_nop 0
  buffer_load_dwordx4 v2, s[52:55], s56 offen offset:0 nt lds
  buffer_load_dwordx4 v3, s[52:55], s56 offen offset:1024 nt lds
  buffer_load_dwordx4 v4, s[52:55], s56 offen offset:2048 nt lds
  buffer_load_dwordx4 v5, s[52:55], s56 offen offset:3072 nt lds
  s_waitcnt vmcnt(4)
  s_mov_b64 exec, 1
  ds_add_u32 v82, v83
L_sb51:
  ds_read_b64 v[80:81], v82
  s_sub_u32 s82, s82, 1
  s_cbranch_scc1 L_sd51
  s_waitcnt lgkmcnt(0)
  v_readfirstlane_b32 s57, v80
  v_readfirstlane_b32 s83, v81
  s_nop 2
  s_cmp_lt_u32 s57, 204
  s_cbranch_scc1 L_sb51
L_sd51:
  s_mov_b64 exec, -1
  v_mfma_f32_16x16x32_bf16 v[144:147], v[96:99], v[132:135], v[144:147]
  v_mfma_f32_16x16x32_bf16 v[148:151], v[100:103], v[132:135], v[148:151]
  v_mfma_f32_16x16x32_bf16 v[152:155], v[104:107], v[132:135], v[152:155]
  v_mfma_f32_16x16x32_bf16 v[156:159], v[108:111], v[132:135], v[156:159]
  v_mfma_f32_16x16x32_bf16 v[160:163], v[112:115], v[132:135], v[160:163]
  v_mfma_f32_16x16x32_bf16 v[164:167], v[116:119], v[132:135], v[164:167]
  v_mfma_f32_16x16x32_bf16 v[168:171], v[120:123], v[132:135], v[168:171]
  v_mfma_f32_16x16x32_bf16 v[172:175], v[124:127], v[132:135], v[172:175]
  v_and_b32 v128, v68, v20
  v_and_b32 v129, v69, v20
  v_and_b32 v130, v70, v20
  v_and_b32 v131, v71, v20
  ds_read_b64_tr_b16 v[96:97], v10 offset:16384
  ds_read_b64_tr_b16 v[100:101], v11 offset:16384
  ds_read_b64_tr_b16 v[104:105], v12 offset:16384
  ds_read_b64_tr_b16 v[108:109], v13 offset:16384
  ds_read_b64_tr_b16 v[112:113], v14 offset:16384
  ds_read_b64_tr_b16 v[116:117], v15 offset:16384
  ds_read_b64_tr_b16 v[120:121], v16 offset:16384
  ds_read_b64_tr_b16 v[124:125], v17 offset:16384
  s_waitcnt lgkmcnt(0)
  s_add_u32 s56, s49, 10485760
  s_and_b32 s56, s56, 0xffffff
  s_add_u32 m0, s48, 16384
  s_nop 0
  buffer_load_dwordx4 v2, s[52:55], s56 offen offset:0 nt lds
  buffer_load_dwordx4 v3, s[52:55], s56 offen offset:1024 nt lds
  buffer_load_dwordx4 v4, s[52:55], s56 offen offset:2048 nt lds
  buffer_load_dwordx4 v5, s[52:55], s56 offen offset:3072 nt lds
  s_waitcnt vmcnt(4)
  s_mov_b64 exec, 1
  ds_add_u32 v82, v83
L_sb52:
  ds_read_b64 v[80:81], v82
  s_sub_u32 s82, s82, 1
  s_cbranch_scc1 L_sd52
  s_waitcnt lgkmcnt(0)
  v_readfirstlane_b32 s57, v80
  v_readfirstlane_b32 s83, v81
  s_nop 2
  s_cmp_lt_u32 s57, 208
  s_cbranch_scc1 L_sb52
L_sd52:
  s_mov_b64 exec, -1
  ds_read_b64_tr_b16 v[98:99], v10 offset:20480
  ds_read_b64_tr_b16 v[102:103], v11 offset:20480
  ds_read_b64_tr_b16 v[106:107], v12 offset:20480
  ds_read_b64_tr_b16 v[110:111], v13 offset:20480
  ds_read_b64_tr_b16 v[114:115], v14 offset:20480
  ds_read_b64_tr_b16 v[118:119], v15 offset:20480
  ds_read_b64_tr_b16 v[122:123], v16 offset:20480
  ds_read_b64_tr_b16 v[126:127], v17 offset:20480
  s_waitcnt lgkmcnt(0)
  s_add_u32 s56, s49, 11010048
  s_and_b32 s56, s56, 0xffffff
  s_add_u32 m0, s48, 20480
  s_nop 0
  buffer_load_dwordx4 v2, s[52:55], s56 offen offset:0 nt lds
  buffer_load_dwordx4 v3, s[52:55], s56 offen offset:1024 nt lds
  buffer_load_dwordx4 v4, s[52:55], s56 offen offset:2048 nt lds
  buffer_load_dwordx4 v5, s[52:55], s56 offen offset:3072 nt lds
  s_waitcnt vmcnt(4)
  s_mov_b64 exec, 1
  ds_add_u32 v82, v83
L_sb53:
  ds_read_b64 v[80:81], v82
  s_sub_u32 s82, s82, 1
  s_cbranch_scc1 L_sd53
  s_waitcnt lgkmcnt(0)
  v_readfirstlane_b32 s57, v80
  v_readfirstlane_b32 s83, v81
  s_nop 2
  s_cmp_lt_u32 s57, 212
  s_cbranch_scc1 L_sb53
L_sd53:
  s_mov_b64 exec, -1
  v_mfma_f32_16x16x32_bf16 v[144:147], v[96:99], v[128:131], v[144:147]
  v_mfma_f32_16x16x32_bf16 v[148:151], v[100:103], v[128:131], v[148:151]
  v_mfma_f32_16x16x32_bf16 v[152:155], v[104:107], v[128:131], v[152:155]
  v_mfma_f32_16x16x32_bf16 v[156:159], v[108:111], v[128:131], v[156:159]
  v_mfma_f32_16x16x32_bf16 v[160:163], v[112:115], v[128:131], v[160:163]
  v_mfma_f32_16x16x32_bf16 v[164:167], v[116:119], v[128:131], v[164:167]
  v_mfma_f32_16x16x32_bf16 v[168:171], v[120:123], v[128:131], v[168:171]
  v_mfma_f32_16x16x32_bf16 v[172:175], v[124:127], v[128:131], v[172:175]
  v_and_b32 v132, v68, v21
  v_and_b32 v133, v69, v21
  v_and_b32 v134, v70, v21
  v_and_b32 v135, v71, v21
  ds_read_b64_tr_b16 v[96:97], v10 offset:24576
  ds_read_b64_tr_b16 v[100:101], v11 offset:24576
  ds_read_b64_tr_b16 v[104:105], v12 offset:24576
  ds_read_b64_tr_b16 v[108:109], v13 offset:24576
  ds_read_b64_tr_b16 v[112:113], v14 offset:24576
  ds_read_b64_tr_b16 v[116:117], v15 offset:24576
  ds_read_b64_tr_b16 v[120:121], v16 offset:24576
  ds_read_b64_tr_b16 v[124:125], v17 offset:24576
  s_waitcnt lgkmcnt(0)
  s_add_u32 s56, s49, 11534336
  s_and_b32 s56, s56, 0xffffff
  s_add_u32 m0, s48, 24576
  s_nop 0
  buffer_load_dwordx4 v2, s[52:55], s56 offen offset:0 nt lds
  buffer_load_dwordx4 v3, s[52:55], s56 offen offset:1024 nt lds
  buffer_load_dwordx4 v4, s[52:55], s56 offen offset:2048 nt lds
  buffer_load_dwordx4 v5, s[52:55], s56 offen offset:3072 nt lds
  s_waitcnt vmcnt(4)
  s_mov_b64 exec, 1
  ds_add_u32 v82, v83
L_sb54:
  ds_read_b64 v[80:81], v82
  s_sub_u32 s82, s82, 1
  s_cbranch_scc1 L_sd54
  s_waitcnt lgkmcnt(0)
  v_readfirstlane_b32 s57, v80
  v_readfirstlane_b32 s83, v81
  s_nop 2
  s_cmp_lt_u32 s57, 216
  s_cbranch_scc1 L_sb54
L_sd54:
  s_mov_b64 exec, -1
  ds_read_b64_tr_b16 v[98:99], v10 offset:28672
  ds_read_b64_tr_b16 v[102:103], v11 offset:28672
  ds_read_b64_tr_b16 v[106:107], v12 offset:28672
  ds_read_b64_tr_b16 v[110:111], v13 offset:28672
  ds_read_b64_tr_b16 v[114:115], v14 offset:28672
  ds_read_b64_tr_b16 v[118:119], v15 offset:28672
  ds_read_b64_tr_b16 v[122:123], v16 offset:28672
  ds_read_b64_tr_b16 v[126:127], v17 offset:28672
  s_waitcnt lgkmcnt(0)
  s_add_u32 s56, s49, 12058624
  s_and_b32 s56, s56, 0xffffff
  s_add_u32 m0, s48, 28672
  s_nop 0
  buffer_load_dwordx4 v2, s[52:55], s56 offen offset:0 nt lds
  buffer_load_dwordx4 v3, s[52:55], s56 offen offset:1024 nt lds
  buffer_load_dwordx4 v4, s[52:55], s56 offen offset:2048 nt lds
  buffer_load_dwordx4 v5, s[52:55], s56 offen offset:3072 nt lds
  s_waitcnt vmcnt(4)
  s_mov_b64 exec, 1
  ds_add_u32 v82, v83
L_sb55:
  ds_read_b64 v[80:81], v82
  s_sub_u32 s82, s82, 1
  s_cbranch_scc1 L_sd55
  s_waitcnt lgkmcnt(0)
  v_readfirstlane_b32 s57, v80
  v_readfirstlane_b32 s83, v81
  s_nop 2
  s_cmp_lt_u32 s57, 220
  s_cbranch_scc1 L_sb55
L_sd55:
  s_mov_b64 exec, -1
  v_mfma_f32_16x16x32_bf16 v[144:147], v[96:99], v[132:135], v[144:147]
  v_mfma_f32_16x16x32_bf16 v[148:151], v[100:103], v[132:135], v[148:151]
  v_mfma_f32_16x16x32_bf16 v[152:155], v[104:107], v[132:135], v[152:155]
  v_mfma_f32_16x16x32_bf16 v[156:159], v[108:111], v[132:135], v[156:159]
  v_mfma_f32_16x16x32_bf16 v[160:163], v[112:115], v[132:135], v[160:163]
  v_mfma_f32_16x16x32_bf16 v[164:167], v[116:119], v[132:135], v[164:167]
  v_mfma_f32_16x16x32_bf16 v[168:171], v[120:123], v[132:135], v[168:171]
  v_mfma_f32_16x16x32_bf16 v[172:175], v[124:127], v[132:135], v[172:175]
  v_and_b32 v128, v72, v18
  v_and_b32 v129, v73, v18
  v_and_b32 v130, v74, v18
  v_and_b32 v131, v75, v18
  ds_read_b64_tr_b16 v[96:97], v10 offset:0
  ds_read_b64_tr_b16 v[100:101], v11 offset:0
  ds_read_b64_tr_b16 v[104:105], v12 offset:0
  ds_read_b64_tr_b16 v[108:109], v13 offset:0
  ds_read_b64_tr_b16 v[112:113], v14 offset:0
  ds_read_b64_tr_b16 v[116:117], v15 offset:0
  ds_read_b64_tr_b16 v[120:121], v16 offset:0
  ds_read_b64_tr_b16 v[124:125], v17 offset:0
  s_waitcnt lgkmcnt(0)
  s_add_u32 s56, s49, 12582912
  s_and_b32 s56, s56, 0xffffff
  s_add_u32 m0, s48, 0
  s_nop 0
  buffer_load_dwordx4 v2, s[52:55], s56 offen offset:0 nt lds
  buffer_load_dwordx4 v3, s[52:55], s56 offen offset:1024 nt lds
  buffer_load_dwordx4 v4, s[52:55], s56 offen offset:2048 nt lds
  buffer_load_dwordx4 v5, s[52:55], s56 offen offset:3072 nt lds
  s_waitcnt vmcnt(4)
  s_mov_b64 exec, 1
  ds_add_u32 v82, v83
L_sb56:
  ds_read_b64 v[80:81], v82
  s_sub_u32 s82, s82, 1
  s_cbranch_scc1 L_sd56
  s_waitcnt lgkmcnt(0)
  v_readfirstlane_b32 s57, v80
  v_readfirstlane_b32 s83, v81
  s_nop 2
  s_cmp_lt_u32 s57, 224
  s_cbranch_scc1 L_sb56
L_sd56:
  s_mov_b64 exec, -1
  ds_read_b64_tr_b16 v[98:99], v10 offset:4096
  ds_read_b64_tr_b16 v[102:103], v11 offset:4096
  ds_read_b64_tr_b16 v[106:107], v12 offset:4096
  ds_read_b64_tr_b16 v[110:111], v13 offset:4096
  ds_read_b64_tr_b16 v[114:115], v14 offset:4096
  ds_read_b64_tr_b16 v[118:119], v15 offset:4096
  ds_read_b64_tr_b16 v[122:123], v16 offset:4096
  ds_read_b64_tr_b16 v[126:127], v17 offset:4096
  s_waitcnt lgkmcnt(0)
  s_add_u32 s56, s49, 13107200
  s_and_b32 s56, s56, 0xffffff
  s_add_u32 m0, s48, 4096
  s_nop 0
  buffer_load_dwordx4 v2, s[52:55], s56 offen offset:0 nt lds
  buffer_load_dwordx4 v3, s[52:55], s56 offen offset:1024 nt lds
  buffer_load_dwordx4 v4, s[52:55], s56 offen offset:2048 nt lds
  buffer_load_dwordx4 v5, s[52:55], s56 offen offset:3072 nt lds
  s_waitcnt vmcnt(4)
  s_mov_b64 exec, 1
  ds_add_u32 v82, v83
L_sb57:
  ds_read_b64 v[80:81], v82
  s_sub_u32 s82, s82, 1
  s_cbranch_scc1 L_sd57
  s_waitcnt lgkmcnt(0)
  v_readfirstlane_b32 s57, v80
  v_readfirstlane_b32 s83, v81
  s_nop 2
  s_cmp_lt_u32 s57, 228
  s_cbranch_scc1 L_sb57
L_sd57:
  s_mov_b64 exec, -1
  v_mfma_f32_16x16x32_bf16 v[144:147], v[96:99], v[128:131], v[144:147]
  v_mfma_f32_16x16x32_bf16 v[148:151], v[100:103], v[128:131], v[148:151]
  v_mfma_f32_16x16x32_bf16 v[152:155], v[104:107], v[128:131], v[152:155]
  v_mfma_f32_16x16x32_bf16 v[156:159], v[108:111], v[128:131], v[156:159]
  v_mfma_f32_16x16x32_bf16 v[160:163], v[112:115], v[128:131], v[160:163]
  v_mfma_f32_16x16x32_bf16 v[164:167], v[116:119], v[128:131], v[164:167]
  v_mfma_f32_16x16x32_bf16 v[168:171], v[120:123], v[128:131], v[168:171]
  v_mfma_f32_16x16x32_bf16 v[172:175], v[124:127], v[128:131], v[172:175]
  v_and_b32 v132, v72, v19
  v_and_b32 v133, v73, v19
  v_and_b32 v134, v74, v19
  v_and_b32 v135, v75, v19
  ds_read_b64_tr_b16 v[96:97], v10 offset:8192
  ds_read_b64_tr_b16 v[100:101], v11 offset:8192
  ds_read_b64_tr_b16 v[104:105], v12 offset:8192
  ds_read_b64_tr_b16 v[108:109], v13 offset:8192
  ds_read_b64_tr_b16 v[112:113], v14 offset:8192
  ds_read_b64_tr_b16 v[116:117], v15 offset:8192
  ds_read_b64_tr_b16 v[120:121], v16 offset:8192
  ds_read_b64_tr_b16 v[124:125], v17 offset:8192
  s_waitcnt lgkmcnt(0)
  s_add_u32 s56, s49, 13631488
  s_and_b32 s56, s56, 0xffffff
  s_add_u32 m0, s48, 8192
  s_nop 0
  buffer_load_dwordx4 v2, s[52:55], s56 offen offset:0 nt lds
  buffer_load_dwordx4 v3, s[52:55], s56 offen offset:1024 nt lds
  buffer_load_dwordx4 v4, s[52:55], s56 offen offset:2048 nt lds
  buffer_load_dwordx4 v5, s[52:55], s56 offen offset:3072 nt lds
  s_waitcnt vmcnt(4)
  s_mov_b64 exec, 1
  ds_add_u32 v82, v83
L_sb58:
  ds_read_b64 v[80:81], v82
  s_sub_u32 s82, s82, 1
  s_cbranch_scc1 L_sd58
  s_waitcnt lgkmcnt(0)
  v_readfirstlane_b32 s57, v80
  v_readfirstlane_b32 s83, v81
  s_nop 2
  s_cmp_lt_u32 s57, 232
  s_cbranch_scc1 L_sb58
L_sd58:
  s_mov_b64 exec, -1
  ds_read_b64_tr_b16 v[98:99], v10 offset:12288
  ds_read_b64_tr_b16 v[102:103], v11 offset:12288
  ds_read_b64_tr_b16 v[106:107], v12 offset:12288
  ds_read_b64_tr_b16 v[110:111], v13 offset:12288
  ds_read_b64_tr_b16 v[114:115], v14 offset:12288
  ds_read_b64_tr_b16 v[118:119], v15 offset:12288
  ds_read_b64_tr_b16 v[122:123], v16 offset:12288
  ds_read_b64_tr_b16 v[126:127], v17 offset:12288
  s_waitcnt lgkmcnt(0)
  s_add_u32 s56, s49, 14155776
  s_and_b32 s56, s56, 0xffffff
  s_add_u32 m0, s48, 12288
  s_nop 0
  buffer_load_dwordx4 v2, s[52:55], s56 offen offset:0 nt lds
  buffer_load_dwordx4 v3, s[52:55], s56 offen offset:1024 nt lds
  buffer_load_dwordx4 v4, s[52:55], s56 offen offset:2048 nt lds
  buffer_load_dwordx4 v5, s[52:55], s56 offen offset:3072 nt lds
  s_waitcnt vmcnt(8)
  v_mfma_f32_16x16x32_bf16 v[144:147], v[96:99], v[132:135], v[144:147]
  v_mfma_f32_16x16x32_bf16 v[148:151], v[100:103], v[132:135], v[148:151]
  v_mfma_f32_16x16x32_bf16 v[152:155], v[104:107], v[132:135], v[152:155]
  v_mfma_f32_16x16x32_bf16 v[156:159], v[108:111], v[132:135], v[156:159]
  v_mfma_f32_16x16x32_bf16 v[160:163], v[112:115], v[132:135], v[160:163]
  v_mfma_f32_16x16x32_bf16 v[164:167], v[116:119], v[132:135], v[164:167]
  v_mfma_f32_16x16x32_bf16 v[168:171], v[120:123], v[132:135], v[168:171]
  v_mfma_f32_16x16x32_bf16 v[172:175], v[124:127], v[132:135], v[172:175]
  v_and_b32 v128, v72, v20
  v_and_b32 v129, v73, v20
  v_and_b32 v130, v74, v20
  v_and_b32 v131, v75, v20
  ds_read_b64_tr_b16 v[96:97], v10 offset:16384
  ds_read_b64_tr_b16 v[100:101], v11 offset:16384
  ds_read_b64_tr_b16 v[104:105], v12 offset:16384
  ds_read_b64_tr_b16 v[108:109], v13 offset:16384
  ds_read_b64_tr_b16 v[112:113], v14 offset:16384
  ds_read_b64_tr_b16 v[116:117], v15 offset:16384
  ds_read_b64_tr_b16 v[120:121], v16 offset:16384
  ds_read_b64_tr_b16 v[124:125], v17 offset:16384
  s_waitcnt lgkmcnt(0)
  s_add_u32 s56, s49, 14680064
  s_and_b32 s56, s56, 0xffffff
  s_add_u32 m0, s48, 16384
  s_nop 0
  buffer_load_dwordx4 v2, s[52:55], s56 offen offset:0 nt lds
  buffer_load_dwordx4 v3, s[52:55], s56 offen offset:1024 nt lds
  buffer_load_dwordx4 v4, s[52:55], s56 offen offset:2048 nt lds
  buffer_load_dwordx4 v5, s[52:55], s56 offen offset:3072 nt lds
  s_waitcnt vmcnt(8)
  ds_read_b64_tr_b16 v[98:99], v10 offset:20480
  ds_read_b64_tr_b16 v[102:103], v11 offset:20480
  ds_read_b64_tr_b16 v[106:107], v12 offset:20480
  ds_read_b64_tr_b16 v[110:111], v13 offset:20480
  ds_read_b64_tr_b16 v[114:115], v14 offset:20480
  ds_read_b64_tr_b16 v[118:119], v15 offset:20480
  ds_read_b64_tr_b16 v[122:123], v16 offset:20480
  ds_read_b64_tr_b16 v[126:127], v17 offset:20480
  s_waitcnt lgkmcnt(0)
  s_add_u32 s56, s49, 15204352
  s_and_b32 s56, s56, 0xffffff
  s_add_u32 m0, s48, 20480
  s_nop 0
  buffer_load_dwordx4 v2, s[52:55], s56 offen offset:0 nt lds
  buffer_load_dwordx4 v3, s[52:55], s56 offen offset:1024 nt lds
  buffer_load_dwordx4 v4, s[52:55], s56 offen offset:2048 nt lds
  buffer_load_dwordx4 v5, s[52:55], s56 offen offset:3072 nt lds
  s_waitcnt vmcnt(8)
  v_mfma_f32_16x16x32_bf16 v[144:147], v[96:99], v[128:131], v[144:147]
  v_mfma_f32_16x16x32_bf16 v[148:151], v[100:103], v[128:131], v[148:151]
  v_mfma_f32_16x16x32_bf16 v[152:155], v[104:107], v[128:131], v[152:155]
  v_mfma_f32_16x16x32_bf16 v[156:159], v[108:111], v[128:131], v[156:159]
  v_mfma_f32_16x16x32_bf16 v[160:163], v[112:115], v[128:131], v[160:163]
  v_mfma_f32_16x16x32_bf16 v[164:167], v[116:119], v[128:131], v[164:167]
  v_mfma_f32_16x16x32_bf16 v[168:171], v[120:123], v[128:131], v[168:171]
  v_mfma_f32_16x16x32_bf16 v[172:175], v[124:127], v[128:131], v[172:175]
  v_and_b32 v132, v72, v21
  v_and_b32 v133, v73, v21
  v_and_b32 v134, v74, v21
  v_and_b32 v135, v75, v21
  ds_read_b64_tr_b16 v[96:97], v10 offset:24576
  ds_read_b64_tr_b16 v[100:101], v11 offset:24576
  ds_read_b64_tr_b16 v[104:105], v12 offset:24576
  ds_read_b64_tr_b16 v[108:109], v13 offset:24576
  ds_read_b64_tr_b16 v[112:113], v14 offset:24576
  ds_read_b64_tr_b16 v[116:117], v15 offset:24576
  ds_read_b64_tr_b16 v[120:121], v16 offset:24576
  ds_read_b64_tr_b16 v[124:125], v17 offset:24576
  s_waitcnt lgkmcnt(0)
  s_add_u32 s56, s49, 15728640
  s_and_b32 s56, s56, 0xffffff
  s_add_u32 m0, s48, 24576
  s_nop 0
  buffer_load_dwordx4 v2, s[52:55], s56 offen offset:0 nt lds
  buffer_load_dwordx4 v3, s[52:55], s56 offen offset:1024 nt lds
  buffer_load_dwordx4 v4, s[52:55], s56 offen offset:2048 nt lds
  buffer_load_dwordx4 v5, s[52:55], s56 offen offset:3072 nt lds
  s_waitcnt vmcnt(8)
  ds_read_b64_tr_b16 v[98:99], v10 offset:28672
  ds_read_b64_tr_b16 v[102:103], v11 offset:28672
  ds_read_b64_tr_b16 v[106:107], v12 offset:28672
  ds_read_b64_tr_b16 v[110:111], v13 offset:28672
  ds_read_b64_tr_b16 v[114:115], v14 offset:28672
  ds_read_b64_tr_b16 v[118:119], v15 offset:28672
  ds_read_b64_tr_b16 v[122:123], v16 offset:28672
  ds_read_b64_tr_b16 v[126:127], v17 offset:28672
  s_waitcnt lgkmcnt(0)
  s_add_u32 s56, s49, 16252928
  s_and_b32 s56, s56, 0xffffff
  s_add_u32 m0, s48, 28672
  s_nop 0
  buffer_load_dwordx4 v2, s[52:55], s56 offen offset:0 nt lds
  buffer_load_dwordx4 v3, s[52:55], s56 offen offset:1024 nt lds
  buffer_load_dwordx4 v4, s[52:55], s56 offen offset:2048 nt lds
  buffer_load_dwordx4 v5, s[52:55], s56 offen offset:3072 nt lds
  v_mfma_f32_16x16x32_bf16 v[144:147], v[96:99], v[132:135], v[144:147]
  v_mfma_f32_16x16x32_bf16 v[148:151], v[100:103], v[132:135], v[148:151]
  v_mfma_f32_16x16x32_bf16 v[152:155], v[104:107], v[132:135], v[152:155]
  v_mfma_f32_16x16x32_bf16 v[156:159], v[108:111], v[132:135], v[156:159]
  v_mfma_f32_16x16x32_bf16 v[160:163], v[112:115], v[132:135], v[160:163]
  v_mfma_f32_16x16x32_bf16 v[164:167], v[116:119], v[132:135], v[164:167]
  v_mfma_f32_16x16x32_bf16 v[168:171], v[120:123], v[132:135], v[168:171]
  v_mfma_f32_16x16x32_bf16 v[172:175], v[124:127], v[132:135], v[172:175]
  v_and_b32 v128, v76, v18
  v_and_b32 v129, v77, v18
  v_and_b32 v130, v78, v18
  v_and_b32 v131, v79, v18
  ds_read_b64_tr_b16 v[96:97], v10 offset:0
  ds_read_b64_tr_b16 v[100:101], v11 offset:0
  ds_read_b64_tr_b16 v[104:105], v12 offset:0
  ds_read_b64_tr_b16 v[108:109], v13 offset:0
  ds_read_b64_tr_b16 v[112:113], v14 offset:0
  ds_read_b64_tr_b16 v[116:117], v15 offset:0
  ds_read_b64_tr_b16 v[120:121], v16 offset:0
  ds_read_b64_tr_b16 v[124:125], v17 offset:0
  s_waitcnt lgkmcnt(0)
  ds_read_b64_tr_b16 v[98:99], v10 offset:4096
  ds_read_b64_tr_b16 v[102:103], v11 offset:4096
  ds_read_b64_tr_b16 v[106:107], v12 offset:4096
  ds_read_b64_tr_b16 v[110:111], v13 offset:4096
  ds_read_b64_tr_b16 v[114:115], v14 offset:4096
  ds_read_b64_tr_b16 v[118:119], v15 offset:4096
  ds_read_b64_tr_b16 v[122:123], v16 offset:4096
  ds_read_b64_tr_b16 v[126:127], v17 offset:4096
  s_waitcnt lgkmcnt(0)
  v_mfma_f32_16x16x32_bf16 v[144:147], v[96:99], v[128:131], v[144:147]
  v_mfma_f32_16x16x32_bf16 v[148:151], v[100:103], v[128:131], v[148:151]
  v_mfma_f32_16x16x32_bf16 v[152:155], v[104:107], v[128:131], v[152:155]
  v_mfma_f32_16x16x32_bf16 v[156:159], v[108:111], v[128:131], v[156:159]
  v_mfma_f32_16x16x32_bf16 v[160:163], v[112:115], v[128:131], v[160:163]
  v_mfma_f32_16x16x32_bf16 v[164:167], v[116:119], v[128:131], v[164:167]
  v_mfma_f32_16x16x32_bf16 v[168:171], v[120:123], v[128:131], v[168:171]
  v_mfma_f32_16x16x32_bf16 v[172:175], v[124:127], v[128:131], v[172:175]
  v_and_b32 v132, v76, v19
  v_and_b32 v133, v77, v19
  v_and_b32 v134, v78, v19
  v_and_b32 v135, v79, v19
  ds_read_b64_tr_b16 v[96:97], v10 offset:8192
  ds_read_b64_tr_b16 v[100:101], v11 offset:8192
  ds_read_b64_tr_b16 v[104:105], v12 offset:8192
  ds_read_b64_tr_b16 v[108:109], v13 offset:8192
  ds_read_b64_tr_b16 v[112:113], v14 offset:8192
  ds_read_b64_tr_b16 v[116:117], v15 offset:8192
  ds_read_b64_tr_b16 v[120:121], v16 offset:8192
  ds_read_b64_tr_b16 v[124:125], v17 offset:8192
  s_waitcnt lgkmcnt(0)
  ds_read_b64_tr_b16 v[98:99], v10 offset:12288
  ds_read_b64_tr_b16 v[102:103], v11 offset:12288
  ds_read_b64_tr_b16 v[106:107], v12 offset:12288
  ds_read_b64_tr_b16 v[110:111], v13 offset:12288
  ds_read_b64_tr_b16 v[114:115], v14 offset:12288
  ds_read_b64_tr_b16 v[118:119], v15 offset:12288
  ds_read_b64_tr_b16 v[122:123], v16 offset:12288
  ds_read_b64_tr_b16 v[126:127], v17 offset:12288
  s_waitcnt lgkmcnt(0)
  v_mfma_f32_16x16x32_bf16 v[144:147], v[96:99], v[132:135], v[144:147]
  v_mfma_f32_16x16x32_bf16 v[148:151], v[100:103], v[132:135], v[148:151]
  v_mfma_f32_16x16x32_bf16 v[152:155], v[104:107], v[132:135], v[152:155]
  v_mfma_f32_16x16x32_bf16 v[156:159], v[108:111], v[132:135], v[156:159]
  v_mfma_f32_16x16x32_bf16 v[160:163], v[112:115], v[132:135], v[160:163]
  v_mfma_f32_16x16x32_bf16 v[164:167], v[116:119], v[132:135], v[164:167]
  v_mfma_f32_16x16x32_bf16 v[168:171], v[120:123], v[132:135], v[168:171]
  v_mfma_f32_16x16x32_bf16 v[172:175], v[124:127], v[132:135], v[172:175]
  v_mov_b32 v27, 161988
  v_mov_b32 v28, 1
  ds_write_b32 v27, v28
  v_and_b32 v128, v76, v20
  v_and_b32 v129, v77, v20
  v_and_b32 v130, v78, v20
  v_and_b32 v131, v79, v20
  ds_read_b64_tr_b16 v[96:97], v10 offset:16384
  ds_read_b64_tr_b16 v[100:101], v11 offset:16384
  ds_read_b64_tr_b16 v[104:105], v12 offset:16384
  ds_read_b64_tr_b16 v[108:109], v13 offset:16384
  ds_read_b64_tr_b16 v[112:113], v14 offset:16384
  ds_read_b64_tr_b16 v[116:117], v15 offset:16384
  ds_read_b64_tr_b16 v[120:121], v16 offset:16384
  ds_read_b64_tr_b16 v[124:125], v17 offset:16384
  s_waitcnt lgkmcnt(0)
  s_waitcnt vmcnt(8)
  ds_read_b64_tr_b16 v[98:99], v10 offset:20480
  ds_read_b64_tr_b16 v[102:103], v11 offset:20480
  ds_read_b64_tr_b16 v[106:107], v12 offset:20480
  ds_read_b64_tr_b16 v[110:111], v13 offset:20480
  ds_read_b64_tr_b16 v[114:115], v14 offset:20480
  ds_read_b64_tr_b16 v[118:119], v15 offset:20480
  ds_read_b64_tr_b16 v[122:123], v16 offset:20480
  ds_read_b64_tr_b16 v[126:127], v17 offset:20480
  s_waitcnt lgkmcnt(0)
  v_mfma_f32_16x16x32_bf16 v[144:147], v[96:99], v[128:131], v[144:147]
  v_mfma_f32_16x16x32_bf16 v[148:151], v[100:103], v[128:131], v[148:151]
  v_mfma_f32_16x16x32_bf16 v[152:155], v[104:107], v[128:131], v[152:155]
  v_mfma_f32_16x16x32_bf16 v[156:159], v[108:111], v[128:131], v[156:159]
  v_mfma_f32_16x16x32_bf16 v[160:163], v[112:115], v[128:131], v[160:163]
  v_mfma_f32_16x16x32_bf16 v[164:167], v[116:119], v[128:131], v[164:167]
  v_mfma_f32_16x16x32_bf16 v[168:171], v[120:123], v[128:131], v[168:171]
  v_mfma_f32_16x16x32_bf16 v[172:175], v[124:127], v[128:131], v[172:175]
  v_mov_b32 v27, 161992
  v_mov_b32 v28, 1
  s_mov_b64 exec, 1
  ds_add_u32 v27, v28
  s_mov_b64 exec, -1
  v_and_b32 v132, v76, v21
  v_and_b32 v133, v77, v21
  v_and_b32 v134, v78, v21
  v_and_b32 v135, v79, v21
  s_waitcnt vmcnt(4)
  ds_read_b64_tr_b16 v[96:97], v10 offset:24576
  ds_read_b64_tr_b16 v[100:101], v11 offset:24576
  ds_read_b64_tr_b16 v[104:105], v12 offset:24576
  ds_read_b64_tr_b16 v[108:109], v13 offset:24576
  ds_read_b64_tr_b16 v[112:113], v14 offset:24576
  ds_read_b64_tr_b16 v[116:117], v15 offset:24576
  ds_read_b64_tr_b16 v[120:121], v16 offset:24576
  ds_read_b64_tr_b16 v[124:125], v17 offset:24576
  s_waitcnt lgkmcnt(0)
  v_mov_b32 v27, 161984
  v_and_b32 v26, 3, v1
  v_lshlrev_b32 v26, 2, v26
  v_add_u32 v26, 161952, v26
  s_mov_b32 s50, 8000000
L_finwf:
  ds_read_b32 v28, v27
  ds_read_b32 v24, v26
  ds_read_b32 v25, v26 offset:16
  s_waitcnt lgkmcnt(0)
  v_readfirstlane_b32 s57, v28
  s_nop 3
  s_cmp_lg_u32 s57, 0
  s_cbranch_scc1 L_findf
  s_sub_u32 s50, s50, 1
  s_cmp_eq_u32 s50, 0
  s_cbranch_scc1 L_findf
  s_sleep 1
  s_branch L_finwf
L_findf:
  v_sub_f32 v24, v22, v24
  v_mul_f32 v24, s59, v24
  v_exp_f32 v24, v24
  s_nop 0
  v_mul_f32 v24, v24, v25
  v_and_b32 v26, 3, v1
  v_lshlrev_b32 v26, 9, v26
  v_lshrrev_b32 v27, 4, v1
  v_lshl_add_u32 v26, v27, 4, v26
  s_lshl_b32 s57, s3, 11
  s_add_u32 s57, s57, 147456
  v_add_u32 v26, s57, v26
  v_and_b32 v34, 15, v1
  v_and_b32 v28, 7, v1
  v_lshl_add_u32 v28, v27, 3, v28
  v_lshrrev_b32 v29, 3, v34
  v_lshl_add_u32 v28, v29, 8, v28
  v_lshlrev_b32 v29, 2, v28
  s_lshl_b32 s57, s3, 8
  s_add_u32 s57, s57, 147456
  v_add_u32 v29, s57, v29
  v_cmp_eq_u32 s[62:63], 8, v34
  v_cmp_eq_u32 s[64:65], 7, v34
  v_min_u32 v35, 8, v34
  v_subrev_u32 v36, 8, v34
  s_nop 0
  v_cndmask_b32 v36, v36, 8, s[64:65]
  v_lshlrev_b32 v37, 6, v27
  s_lshl_b32 s57, s42, 12
  s_lshl_b32 s56, s3, 9
  s_add_u32 s57, s57, s56
  s_add_u32 s57, s57, 917504
  v_lshl_add_u32 v32, v35, 2, v37
  v_add_u32 v32, s57, v32
  v_lshl_add_u32 v33, v36, 2, v37
  v_add_u32 v33, s57, v33
  s_waitcnt vmcnt(0)
  ds_read_b64_tr_b16 v[98:99], v10 offset:28672
  ds_read_b64_tr_b16 v[102:103], v11 offset:28672
  ds_read_b64_tr_b16 v[106:107], v12 offset:28672
  ds_read_b64_tr_b16 v[110:111], v13 offset:28672
  ds_read_b64_tr_b16 v[114:115], v14 offset:28672
  ds_read_b64_tr_b16 v[118:119], v15 offset:28672
  ds_read_b64_tr_b16 v[122:123], v16 offset:28672
  ds_read_b64_tr_b16 v[126:127], v17 offset:28672
  s_waitcnt lgkmcnt(0)
  v_mfma_f32_16x16x32_bf16 v[144:147], v[96:99], v[132:135], v[144:147]
  v_mfma_f32_16x16x32_bf16 v[148:151], v[100:103], v[132:135], v[148:151]
  v_mfma_f32_16x16x32_bf16 v[152:155], v[104:107], v[132:135], v[152:155]
  v_mfma_f32_16x16x32_bf16 v[156:159], v[108:111], v[132:135], v[156:159]
  v_mfma_f32_16x16x32_bf16 v[160:163], v[112:115], v[132:135], v[160:163]
  v_mfma_f32_16x16x32_bf16 v[164:167], v[116:119], v[132:135], v[164:167]
  v_mfma_f32_16x16x32_bf16 v[168:171], v[120:123], v[132:135], v[168:171]
  v_mfma_f32_16x16x32_bf16 v[172:175], v[124:127], v[132:135], v[172:175]
  s_nop 3
  v_mul_f32 v144, v24, v144
  v_mul_f32 v145, v24, v145
  v_mul_f32 v146, v24, v146
  v_mul_f32 v147, v24, v147
  v_mul_f32 v148, v24, v148
  v_mul_f32 v149, v24, v149
  v_mul_f32 v150, v24, v150
  v_mul_f32 v151, v24, v151
  v_mul_f32 v152, v24, v152
  v_mul_f32 v153, v24, v153
  v_mul_f32 v154, v24, v154
  v_mul_f32 v155, v24, v155
  v_mul_f32 v156, v24, v156
  v_mul_f32 v157, v24, v157
  v_mul_f32 v158, v24, v158
  v_mul_f32 v159, v24, v159
  v_mul_f32 v160, v24, v160
  v_mul_f32 v161, v24, v161
  v_mul_f32 v162, v24, v162
  v_mul_f32 v163, v24, v163
  v_mul_f32 v164, v24, v164
  v_mul_f32 v165, v24, v165
  v_mul_f32 v166, v24, v166
  v_mul_f32 v167, v24, v167
  v_mul_f32 v168, v24, v168
  v_mul_f32 v169, v24, v169
  v_mul_f32 v170, v24, v170
  v_mul_f32 v171, v24, v171
  v_mul_f32 v172, v24, v172
  v_mul_f32 v173, v24, v173
  v_mul_f32 v174, v24, v174
  v_mul_f32 v175, v24, v175
  v_add_f32_dpp v144, v144, v144 row_ror:4 row_mask:0xf bank_mask:0xf
  v_add_f32_dpp v145, v145, v145 row_ror:4 row_mask:0xf bank_mask:0xf
  v_add_f32_dpp v146, v146, v146 row_ror:4 row_mask:0xf bank_mask:0xf
  v_add_f32_dpp v147, v147, v147 row_ror:4 row_mask:0xf bank_mask:0xf
  v_add_f32_dpp v148, v148, v148 row_ror:4 row_mask:0xf bank_mask:0xf
  v_add_f32_dpp v149, v149, v149 row_ror:4 row_mask:0xf bank_mask:0xf
  v_add_f32_dpp v150, v150, v150 row_ror:4 row_mask:0xf bank_mask:0xf
  v_add_f32_dpp v151, v151, v151 row_ror:4 row_mask:0xf bank_mask:0xf
  v_add_f32_dpp v152, v152, v152 row_ror:4 row_mask:0xf bank_mask:0xf
  v_add_f32_dpp v153, v153, v153 row_ror:4 row_mask:0xf bank_mask:0xf
  v_add_f32_dpp v154, v154, v154 row_ror:4 row_mask:0xf bank_mask:0xf
  v_add_f32_dpp v155, v155, v155 row_ror:4 row_mask:0xf bank_mask:0xf
  v_add_f32_dpp v156, v156, v156 row_ror:4 row_mask:0xf bank_mask:0xf
  v_add_f32_dpp v157, v157, v157 row_ror:4 row_mask:0xf bank_mask:0xf
  v_add_f32_dpp v158, v158, v158 row_ror:4 row_mask:0xf bank_mask:0xf
  v_add_f32_dpp v159, v159, v159 row_ror:4 row_mask:0xf bank_mask:0xf
  v_add_f32_dpp v160, v160, v160 row_ror:4 row_mask:0xf bank_mask:0xf
  v_add_f32_dpp v161, v161, v161 row_ror:4 row_mask:0xf bank_mask:0xf
  v_add_f32_dpp v162, v162, v162 row_ror:4 row_mask:0xf bank_mask:0xf
  v_add_f32_dpp v163, v163, v163 row_ror:4 row_mask:0xf bank_mask:0xf
  v_add_f32_dpp v164, v164, v164 row_ror:4 row_mask:0xf bank_mask:0xf
  v_add_f32_dpp v165, v165, v165 row_ror:4 row_mask:0xf bank_mask:0xf
  v_add_f32_dpp v166, v166, v166 row_ror:4 row_mask:0xf bank_mask:0xf
  v_add_f32_dpp v167, v167, v167 row_ror:4 row_mask:0xf bank_mask:0xf
  v_add_f32_dpp v168, v168, v168 row_ror:4 row_mask:0xf bank_mask:0xf
  v_add_f32_dpp v169, v169, v169 row_ror:4 row_mask:0xf bank_mask:0xf
  v_add_f32_dpp v170, v170, v170 row_ror:4 row_mask:0xf bank_mask:0xf
  v_add_f32_dpp v171, v171, v171 row_ror:4 row_mask:0xf bank_mask:0xf
  v_add_f32_dpp v172, v172, v172 row_ror:4 row_mask:0xf bank_mask:0xf
  v_add_f32_dpp v173, v173, v173 row_ror:4 row_mask:0xf bank_mask:0xf
  v_add_f32_dpp v174, v174, v174 row_ror:4 row_mask:0xf bank_mask:0xf
  v_add_f32_dpp v175, v175, v175 row_ror:4 row_mask:0xf bank_mask:0xf
  v_add_f32_dpp v144, v144, v144 row_ror:8 row_mask:0xf bank_mask:0xf
  v_add_f32_dpp v145, v145, v145 row_ror:8 row_mask:0xf bank_mask:0xf
  v_add_f32_dpp v146, v146, v146 row_ror:8 row_mask:0xf bank_mask:0xf
  v_add_f32_dpp v147, v147, v147 row_ror:8 row_mask:0xf bank_mask:0xf
  v_add_f32_dpp v148, v148, v148 row_ror:8 row_mask:0xf bank_mask:0xf
  v_add_f32_dpp v149, v149, v149 row_ror:8 row_mask:0xf bank_mask:0xf
  v_add_f32_dpp v150, v150, v150 row_ror:8 row_mask:0xf bank_mask:0xf
  v_add_f32_dpp v151, v151, v151 row_ror:8 row_mask:0xf bank_mask:0xf
  v_add_f32_dpp v152, v152, v152 row_ror:8 row_mask:0xf bank_mask:0xf
  v_add_f32_dpp v153, v153, v153 row_ror:8 row_mask:0xf bank_mask:0xf
  v_add_f32_dpp v154, v154, v154 row_ror:8 row_mask:0xf bank_mask:0xf
  v_add_f32_dpp v155, v155, v155 row_ror:8 row_mask:0xf bank_mask:0xf
  v_add_f32_dpp v156, v156, v156 row_ror:8 row_mask:0xf bank_mask:0xf
  v_add_f32_dpp v157, v157, v157 row_ror:8 row_mask:0xf bank_mask:0xf
  v_add_f32_dpp v158, v158, v158 row_ror:8 row_mask:0xf bank_mask:0xf
  v_add_f32_dpp v159, v159, v159 row_ror:8 row_mask:0xf bank_mask:0xf
  v_add_f32_dpp v160, v160, v160 row_ror:8 row_mask:0xf bank_mask:0xf
  v_add_f32_dpp v161, v161, v161 row_ror:8 row_mask:0xf bank_mask:0xf
  v_add_f32_dpp v162, v162, v162 row_ror:8 row_mask:0xf bank_mask:0xf
  v_add_f32_dpp v163, v163, v163 row_ror:8 row_mask:0xf bank_mask:0xf
  v_add_f32_dpp v164, v164, v164 row_ror:8 row_mask:0xf bank_mask:0xf
  v_add_f32_dpp v165, v165, v165 row_ror:8 row_mask:0xf bank_mask:0xf
  v_add_f32_dpp v166, v166, v166 row_ror:8 row_mask:0xf bank_mask:0xf
  v_add_f32_dpp v167, v167, v167 row_ror:8 row_mask:0xf bank_mask:0xf
  v_add_f32_dpp v168, v168, v168 row_ror:8 row_mask:0xf bank_mask:0xf
  v_add_f32_dpp v169, v169, v169 row_ror:8 row_mask:0xf bank_mask:0xf
  v_add_f32_dpp v170, v170, v170 row_ror:8 row_mask:0xf bank_mask:0xf
  v_add_f32_dpp v171, v171, v171 row_ror:8 row_mask:0xf bank_mask:0xf
  v_add_f32_dpp v172, v172, v172 row_ror:8 row_mask:0xf bank_mask:0xf
  v_add_f32_dpp v173, v173, v173 row_ror:8 row_mask:0xf bank_mask:0xf
  v_add_f32_dpp v174, v174, v174 row_ror:8 row_mask:0xf bank_mask:0xf
  v_add_f32_dpp v175, v175, v175 row_ror:8 row_mask:0xf bank_mask:0xf
  s_mov_b32 exec_lo, 0x000f000f
  s_mov_b32 exec_hi, 0x000f000f
  ds_write_b128 v26, v[144:147] offset:0
  ds_write_b128 v26, v[148:151] offset:64
  ds_write_b128 v26, v[152:155] offset:128
  ds_write_b128 v26, v[156:159] offset:192
  ds_write_b128 v26, v[160:163] offset:256
  ds_write_b128 v26, v[164:167] offset:320
  ds_write_b128 v26, v[168:171] offset:384
  ds_write_b128 v26, v[172:175] offset:448
  s_mov_b64 exec, -1
  s_waitcnt lgkmcnt(0)
  s_barrier
  ds_read_b32 v40, v29 offset:0
  ds_read_b32 v41, v29 offset:2048
  ds_read_b32 v42, v29 offset:4096
  ds_read_b32 v43, v29 offset:6144
  ds_read_b32 v44, v29 offset:128
  ds_read_b32 v45, v29 offset:2176
  ds_read_b32 v46, v29 offset:4224
  ds_read_b32 v47, v29 offset:6272
  s_waitcnt lgkmcnt(4)
  v_add_f32 v40, v40, v41
  v_add_f32 v42, v42, v43
  v_add_f32 v40, v40, v42
  v_cndmask_b32 v41, v40, 1.0, s[62:63]
  v_cndmask_b32 v42, v40, 1.0, s[64:65]
  s_waitcnt lgkmcnt(0)
  v_add_f32 v44, v44, v45
  v_add_f32 v46, v46, v47
  v_add_f32 v44, v44, v46
  v_cndmask_b32 v45, v44, 1.0, s[62:63]
  v_cndmask_b32 v46, v44, 1.0, s[64:65]
  s_mov_b32 exec_lo, 0x01ff01ff
  s_mov_b32 exec_hi, 0x01ff01ff
  global_atomic_add_f32 v32, v41, s[40:41] offset:0 sc1
  global_atomic_add_f32 v32, v45, s[40:41] offset:256 sc1
  s_mov_b32 exec_lo, 0xff80ff80
  s_mov_b32 exec_hi, 0xff80ff80
  global_atomic_add_f32 v33, v42, s[40:41] offset:2048 sc1
  global_atomic_add_f32 v33, v46, s[40:41] offset:2304 sc1
  s_mov_b64 exec, -1
  s_endpgm
L_helper:
  v_lshlrev_b32 v28, 2, v1
  v_add_u32 v28, 161920, v28
  v_mov_b32 v32, 0
  s_mov_b64 exec, 0xffffff
  ds_write_b32 v28, v32
  s_mov_b64 exec, -1
  v_lshlrev_b32 v2, 4, v1
  s_lshr_b32 s60, s43, 2
  s_and_b32 s61, s43, 3
  s_lshl_b32 s51, s60, 7
  s_lshl_b32 s49, s42, 4
  s_add_u32 s51, s51, s49
  s_lshl_b32 s49, s61, 2
  s_add_u32 s51, s51, s49
  v_lshrrev_b32 v3, 3, v1
  v_lshlrev_b32 v3, 13, v3
  v_and_b32 v4, 7, v1
  v_lshl_or_b32 v3, v4, 4, v3
  s_lshl_b32 s48, s42, 10
  s_lshl_b32 s49, s43, 5
  s_add_u32 s48, s48, s49
  s_and_b32 s44, s43, 7
  s_lshr_b32 s45, s43, 3
  s_lshl_b32 s56, s45, 20
  s_lshl_b32 s49, s42, 10
  s_add_u32 s56, s56, s49
  s_lshl_b32 s49, s44, 7
  s_add_u32 s56, s56, s49
  s_waitcnt lgkmcnt(0)
  global_load_dwordx4 v[24:27], v2, s[16:17]
  s_mov_b32 s52, s22
  s_and_b32 s53, s23, 0xffff
  s_mov_b32 s54, 4194304
  s_mov_b32 s55, 0x20000
  s_mov_b32 m0, 131072
  s_nop 0
  buffer_load_dwordx4 v3, s[52:55], s56 offen nt lds
  s_add_u32 s56, s56, 65536
  s_mov_b32 m0, 132096
  s_nop 0
  buffer_load_dwordx4 v3, s[52:55], s56 offen nt lds
  s_add_u32 s56, s56, 65536
  s_mov_b32 m0, 133120
  s_nop 0
  buffer_load_dwordx4 v3, s[52:55], s56 offen nt lds
  s_add_u32 s56, s56, 65536
  s_mov_b32 m0, 134144
  s_nop 0
  buffer_load_dwordx4 v3, s[52:55], s56 offen nt lds
  s_add_u32 s56, s56, 65536
  s_mov_b32 m0, 135168
  s_nop 0
  buffer_load_dwordx4 v3, s[52:55], s56 offen nt lds
  s_add_u32 s56, s56, 65536
  s_mov_b32 m0, 136192
  s_nop 0
  buffer_load_dwordx4 v3, s[52:55], s56 offen nt lds
  s_add_u32 s56, s56, 65536
  s_mov_b32 m0, 137216
  s_nop 0
  buffer_load_dwordx4 v3, s[52:55], s56 offen nt lds
  s_add_u32 s56, s56, 65536
  s_mov_b32 m0, 138240
  s_nop 0
  buffer_load_dwordx4 v3, s[52:55], s56 offen nt lds
  s_add_u32 s56, s56, 65536
  s_mov_b32 m0, 139264
  s_nop 0
  buffer_load_dwordx4 v3, s[52:55], s56 offen nt lds
  s_add_u32 s56, s56, 65536
  s_mov_b32 m0, 140288
  s_nop 0
  buffer_load_dwordx4 v3, s[52:55], s56 offen nt lds
  s_add_u32 s56, s56, 65536
  s_mov_b32 m0, 141312
  s_nop 0
  buffer_load_dwordx4 v3, s[52:55], s56 offen nt lds
  s_add_u32 s56, s56, 65536
  s_mov_b32 m0, 142336
  s_nop 0
  buffer_load_dwordx4 v3, s[52:55], s56 offen nt lds
  s_add_u32 s56, s56, 65536
  s_mov_b32 m0, 143360
  s_nop 0
  buffer_load_dwordx4 v3, s[52:55], s56 offen nt lds
  s_add_u32 s56, s56, 65536
  s_mov_b32 m0, 144384
  s_nop 0
  buffer_load_dwordx4 v3, s[52:55], s56 offen nt lds
  s_add_u32 s56, s56, 65536
  s_mov_b32 m0, 145408
  s_nop 0
  buffer_load_dwordx4 v3, s[52:55], s56 offen nt lds
  s_add_u32 s56, s56, 65536
  s_mov_b32 m0, 146432
  s_nop 0
  buffer_load_dwordx4 v3, s[52:55], s56 offen nt lds
  s_add_u32 s56, s56, 65536
  s_barrier
  s_lshl_b32 s49, s47, 7
  s_add_u32 s49, s49, 917504
  v_add_u32 v28, s49, v2
  v_mov_b32 v32, 0
  v_mov_b32 v33, 0
  v_mov_b32 v34, 0
  v_mov_b32 v35, 0
  s_mov_b64 exec, 0xff
  global_store_dwordx4 v28, v[32:35], s[40:41] sc1
  s_lshl_b32 s49, s51, 1
  s_add_u32 s49, s49, 49152
  v_mov_b32 v28, s49
  s_mov_b64 exec, 1
  global_store_dwordx2 v28, v[32:33], s[40:41] sc1
  s_mov_b64 exec, -1
  s_lshl_b32 s46, s47, 7
  s_add_u32 s46, s46, 851968
  v_add_u32 v28, s46, v2
  s_lshl_b32 s49, s42, 9
  s_add_u32 s49, s49, 32768
  v_mov_b32 v29, s49
  v_cmp_eq_u32 vcc, 8, v1
  s_nop 1
  v_cndmask_b32 v28, v28, v29, vcc
  s_movk_i32 s56, 0xff
  s_cmp_eq_u32 s43, 0
  s_cselect_b32 exec_lo, 0x1ff, s56
  s_mov_b32 exec_hi, 0
  global_store_dwordx4 v28, v[32:35], s[40:41] sc1
  s_mov_b64 exec, -1
  s_or_b32 s49, s42, s61
  s_cmp_lg_u32 s49, 0
  s_cbranch_scc1 L_nozs
  s_lshl_b32 s49, s60, 9
  s_add_u32 s49, s49, 40960
  v_add_u32 v28, s49, v2
  s_mov_b32 exec_hi, 0
  global_store_dwordx4 v28, v[32:35], s[40:41] sc1
  s_mov_b64 exec, -1
L_nozs:
  s_waitcnt vmcnt(19)
  v_lshlrev_b32 v8, 16, v24
  v_and_b32 v9, 0xffff0000, v24
  v_lshlrev_b32 v10, 16, v25
  v_and_b32 v11, 0xffff0000, v25
  v_lshlrev_b32 v12, 16, v26
  v_and_b32 v13, 0xffff0000, v26
  v_lshlrev_b32 v14, 16, v27
  v_and_b32 v15, 0xffff0000, v27
  v_add_f32 v16, v8, v9
  v_add_f32 v17, v10, v11
  v_add_f32 v18, v12, v13
  v_add_f32 v19, v14, v15
  v_add_f32 v16, v16, v17
  v_add_f32 v18, v18, v19
  v_add_f32 v16, v16, v18
  s_nop 1
  v_add_f32_dpp v16, v16, v16 row_ror:1 row_mask:0xf bank_mask:0xf
  s_nop 1
  v_add_f32_dpp v16, v16, v16 row_ror:2 row_mask:0xf bank_mask:0xf
  s_nop 1
  v_add_f32_dpp v16, v16, v16 row_ror:4 row_mask:0xf bank_mask:0xf
  s_nop 1
  v_add_f32_dpp v16, v16, v16 row_ror:8 row_mask:0xf bank_mask:0xf
  v_mov_b32 v17, v16
  s_nop 1
  v_permlane16_swap_b32 v16, v17
  s_nop 1
  v_add_f32 v16, v16, v17
  v_mov_b32 v17, v16
  s_nop 1
  v_permlane32_swap_b32 v16, v17
  s_nop 1
  v_add_f32 v16, v16, v17
  v_mul_f32 v16, 0x3b000000, v16
  v_sub_f32 v18, v8, v16
  v_mul_f32 v17, v18, v18
  v_sub_f32 v18, v9, v16
  v_fmac_f32 v17, v18, v18
  v_sub_f32 v18, v10, v16
  v_fmac_f32 v17, v18, v18
  v_sub_f32 v18, v11, v16
  v_fmac_f32 v17, v18, v18
  v_sub_f32 v18, v12, v16
  v_fmac_f32 v17, v18, v18
  v_sub_f32 v18, v13, v16
  v_fmac_f32 v17, v18, v18
  v_sub_f32 v18, v14, v16
  v_fmac_f32 v17, v18, v18
  v_sub_f32 v18, v15, v16
  v_fmac_f32 v17, v18, v18
  s_nop 1
  v_add_f32_dpp v17, v17, v17 row_ror:1 row_mask:0xf bank_mask:0xf
  s_nop 1
  v_add_f32_dpp v17, v17, v17 row_ror:2 row_mask:0xf bank_mask:0xf
  s_nop 1
  v_add_f32_dpp v17, v17, v17 row_ror:4 row_mask:0xf bank_mask:0xf
  s_nop 1
  v_add_f32_dpp v17, v17, v17 row_ror:8 row_mask:0xf bank_mask:0xf
  v_mov_b32 v18, v17
  s_nop 1
  v_permlane16_swap_b32 v17, v18
  s_nop 1
  v_add_f32 v17, v17, v18
  v_mov_b32 v18, v17
  s_nop 1
  v_permlane32_swap_b32 v17, v18
  s_nop 1
  v_add_f32 v17, v17, v18
  v_mul_f32 v17, 0x3b000000, v17
  v_cvt_pk_bf16_f32 v16, v16, v16
  v_lshlrev_b32 v16, 16, v16
  v_cvt_pk_bf16_f32 v17, v17, v17
  v_lshlrev_b32 v17, 16, v17
  v_add_f32 v17, 0x3727c5ac, v17
  v_cvt_pk_bf16_f32 v17, v17, v17
  v_lshlrev_b32 v17, 16, v17
  v_sqrt_f32 v18, v17
  v_rsq_f32 v19, v17
  s_nop 0
  v_fma_f32 v20, -v18, v18, v17
  v_mul_f32 v19, 0.5, v19
  v_fmac_f32 v18, v20, v19
  v_cvt_pk_bf16_f32 v18, v18, v18
  v_lshlrev_b32 v18, 16, v18
  v_rcp_f32 v19, v18
  v_sub_f32 v8, v8, v16
  v_sub_f32 v9, v9, v16
  v_sub_f32 v10, v10, v16
  v_sub_f32 v11, v11, v16
  v_sub_f32 v12, v12, v16
  v_sub_f32 v13, v13, v16
  v_sub_f32 v14, v14, v16
  v_sub_f32 v15, v15, v16
  v_cvt_pk_bf16_f32 v8, v8, v8
  v_lshlrev_b32 v8, 16, v8
  v_cvt_pk_bf16_f32 v9, v9, v9
  v_lshlrev_b32 v9, 16, v9
  v_cvt_pk_bf16_f32 v10, v10, v10
  v_lshlrev_b32 v10, 16, v10
  v_cvt_pk_bf16_f32 v11, v11, v11
  v_lshlrev_b32 v11, 16, v11
  v_cvt_pk_bf16_f32 v12, v12, v12
  v_lshlrev_b32 v12, 16, v12
  v_cvt_pk_bf16_f32 v13, v13, v13
  v_lshlrev_b32 v13, 16, v13
  v_cvt_pk_bf16_f32 v14, v14, v14
  v_lshlrev_b32 v14, 16, v14
  v_cvt_pk_bf16_f32 v15, v15, v15
  v_lshlrev_b32 v15, 16, v15
  v_mul_f32 v20, v8, v19
  v_fma_f32 v21, -v20, v18, v8
  v_fma_f32 v8, v21, v19, v20
  v_mul_f32 v20, v9, v19
  v_fma_f32 v21, -v20, v18, v9
  v_fma_f32 v9, v21, v19, v20
  v_mul_f32 v20, v10, v19
  v_fma_f32 v21, -v20, v18, v10
  v_fma_f32 v10, v21, v19, v20
  v_mul_f32 v20, v11, v19
  v_fma_f32 v21, -v20, v18, v11
  v_fma_f32 v11, v21, v19, v20
  v_mul_f32 v20, v12, v19
  v_fma_f32 v21, -v20, v18, v12
  v_fma_f32 v12, v21, v19, v20
  v_mul_f32 v20, v13, v19
  v_fma_f32 v21, -v20, v18, v13
  v_fma_f32 v13, v21, v19, v20
  v_mul_f32 v20, v14, v19
  v_fma_f32 v21, -v20, v18, v14
  v_fma_f32 v14, v21, v19, v20
  v_mul_f32 v20, v15, v19
  v_fma_f32 v21, -v20, v18, v15
  v_fma_f32 v15, v21, v19, v20
  v_cvt_pk_bf16_f32 v24, v8, v9
  v_cvt_pk_bf16_f32 v25, v10, v11
  v_cvt_pk_bf16_f32 v26, v12, v13
  v_cvt_pk_bf16_f32 v27, v14, v15
  v_lshlrev_b32 v8, 16, v24
  v_and_b32 v9, 0xffff0000, v24
  v_lshlrev_b32 v10, 16, v25
  v_and_b32 v11, 0xffff0000, v25
  v_lshlrev_b32 v12, 16, v26
  v_and_b32 v13, 0xffff0000, v26
  v_lshlrev_b32 v14, 16, v27
  v_and_b32 v15, 0xffff0000, v27
  v_add_u32 v28, 159744, v2
  ds_write_b128 v28, v[24:27]
  v_lshrrev_b32 v29, 4, v1
  v_lshlrev_b32 v30, 4, v29
  s_lshl_b32 s49, s45, 8
  s_add_u32 s49, s49, 159744
  v_add_u32 v30, s49, v30
  v_bfe_u32 v31, v1, 2, 2
  v_lshl_add_u32 v31, v29, 3, v31
  v_lshlrev_b32 v31, 7, v31
  v_and_b32 v28, 3, v1
  v_lshl_add_u32 v31, v28, 3, v31
  v_add_u32 v31, 131072, v31
  v_and_b32 v28, 15, v1
  v_lshlrev_b32 v28, 6, v28
  v_lshl_add_u32 v29, v29, 4, v28
  s_lshl_b32 s49, s42, 13
  s_lshl_b32 s56, s45, 11
  s_add_u32 s49, s49, s56
  s_lshl_b32 s56, s44, 8
  s_add_u32 s49, s49, s56
  s_add_u32 s49, s49, 786432
  v_add_u32 v29, s49, v29
  v_and_b32 v28, 15, v1
  s_waitcnt lgkmcnt(0)
  ds_read_b128 v[64:67], v30 offset:0
  ds_read_b128 v[68:71], v30 offset:64
  ds_read_b128 v[72:75], v30 offset:128
  ds_read_b128 v[76:79], v30 offset:192
  s_waitcnt vmcnt(0)
  ds_read_b64_tr_b16 v[128:129], v31 offset:0
  ds_read_b64_tr_b16 v[130:131], v31 offset:512
  ds_read_b64_tr_b16 v[132:133], v31 offset:32
  ds_read_b64_tr_b16 v[134:135], v31 offset:544
  ds_read_b64_tr_b16 v[136:137], v31 offset:64
  ds_read_b64_tr_b16 v[138:139], v31 offset:576
  ds_read_b64_tr_b16 v[140:141], v31 offset:96
  ds_read_b64_tr_b16 v[142:143], v31 offset:608
  s_waitcnt lgkmcnt(0)
  v_mfma_f32_16x16x32_bf16 v[32:35], v[128:131], v[64:67], 0
  v_mfma_f32_16x16x32_bf16 v[36:39], v[132:135], v[64:67], 0
  v_mfma_f32_16x16x32_bf16 v[40:43], v[136:139], v[64:67], 0
  v_mfma_f32_16x16x32_bf16 v[44:47], v[140:143], v[64:67], 0
  ds_read_b64_tr_b16 v[144:145], v31 offset:4096
  ds_read_b64_tr_b16 v[146:147], v31 offset:4608
  ds_read_b64_tr_b16 v[148:149], v31 offset:4128
  ds_read_b64_tr_b16 v[150:151], v31 offset:4640
  ds_read_b64_tr_b16 v[152:153], v31 offset:4160
  ds_read_b64_tr_b16 v[154:155], v31 offset:4672
  ds_read_b64_tr_b16 v[156:157], v31 offset:4192
  ds_read_b64_tr_b16 v[158:159], v31 offset:4704
  s_waitcnt lgkmcnt(0)
  v_mfma_f32_16x16x32_bf16 v[32:35], v[144:147], v[68:71], v[32:35]
  v_mfma_f32_16x16x32_bf16 v[36:39], v[148:151], v[68:71], v[36:39]
  v_mfma_f32_16x16x32_bf16 v[40:43], v[152:155], v[68:71], v[40:43]
  v_mfma_f32_16x16x32_bf16 v[44:47], v[156:159], v[68:71], v[44:47]
  ds_read_b64_tr_b16 v[160:161], v31 offset:8192
  ds_read_b64_tr_b16 v[162:163], v31 offset:8704
  ds_read_b64_tr_b16 v[164:165], v31 offset:8224
  ds_read_b64_tr_b16 v[166:167], v31 offset:8736
  ds_read_b64_tr_b16 v[168:169], v31 offset:8256
  ds_read_b64_tr_b16 v[170:171], v31 offset:8768
  ds_read_b64_tr_b16 v[172:173], v31 offset:8288
  ds_read_b64_tr_b16 v[174:175], v31 offset:8800
  s_waitcnt lgkmcnt(0)
  v_mfma_f32_16x16x32_bf16 v[32:35], v[160:163], v[72:75], v[32:35]
  v_mfma_f32_16x16x32_bf16 v[36:39], v[164:167], v[72:75], v[36:39]
  v_mfma_f32_16x16x32_bf16 v[40:43], v[168:171], v[72:75], v[40:43]
  v_mfma_f32_16x16x32_bf16 v[44:47], v[172:175], v[72:75], v[44:47]
  ds_read_b64_tr_b16 v[176:177], v31 offset:12288
  ds_read_b64_tr_b16 v[178:179], v31 offset:12800
  ds_read_b64_tr_b16 v[180:181], v31 offset:12320
  ds_read_b64_tr_b16 v[182:183], v31 offset:12832
  ds_read_b64_tr_b16 v[184:185], v31 offset:12352
  ds_read_b64_tr_b16 v[186:187], v31 offset:12864
  ds_read_b64_tr_b16 v[188:189], v31 offset:12384
  ds_read_b64_tr_b16 v[190:191], v31 offset:12896
  s_waitcnt lgkmcnt(0)
  v_mfma_f32_16x16x32_bf16 v[32:35], v[176:179], v[76:79], v[32:35]
  v_mfma_f32_16x16x32_bf16 v[36:39], v[180:183], v[76:79], v[36:39]
  v_mfma_f32_16x16x32_bf16 v[40:43], v[184:187], v[76:79], v[40:43]
  v_mfma_f32_16x16x32_bf16 v[44:47], v[188:191], v[76:79], v[44:47]
  v_cmp_eq_u32 s[52:53], 1, v28
  v_cmp_eq_u32 s[54:55], 2, v28
  v_cmp_eq_u32 vcc, 3, v28
  s_nop 5
  v_cndmask_b32 v32, v32, v36, s[52:53]
  v_cndmask_b32 v33, v33, v37, s[52:53]
  v_cndmask_b32 v34, v34, v38, s[52:53]
  v_cndmask_b32 v35, v35, v39, s[52:53]
  v_cndmask_b32 v32, v32, v40, s[54:55]
  v_cndmask_b32 v33, v33, v41, s[54:55]
  v_cndmask_b32 v34, v34, v42, s[54:55]
  v_cndmask_b32 v35, v35, v43, s[54:55]
  v_cndmask_b32 v32, v32, v44, vcc
  v_cndmask_b32 v33, v33, v45, vcc
  v_cndmask_b32 v34, v34, v46, vcc
  v_cndmask_b32 v35, v35, v47, vcc
  s_mov_b32 exec_lo, 0x000f000f
  s_mov_b32 exec_hi, 0x000f000f
  global_store_dwordx4 v29, v[32:35], s[40:41] sc1
  s_mov_b64 exec, -1
  s_waitcnt vmcnt(0)
  s_lshl_b32 s49, s42, 5
  v_mov_b32 v3, s49
  v_mov_b32 v30, 1
  s_lshl_b32 s49, s42, 12
  s_add_u32 s49, s49, 851968
  v_lshlrev_b32 v38, 7, v1
  v_add_u32 v38, s49, v38
  v_mov_b32 v39, s46
  s_waitcnt vmcnt(0)
  s_mov_b64 exec, 1
  global_atomic_add v4, v3, v30, s[38:39] offset:0 sc0 sc1
  s_mov_b32 s50, 400000
  s_waitcnt vmcnt(0)
  v_readfirstlane_b32 s57, v4
  s_nop 3
  s_and_b32 s57, s57, 31
  s_cmp_lg_u32 s57, 31
  s_cbranch_scc1 L_aw_q
  s_mov_b32 exec_lo, -1
  global_store_dword v38, v30, s[40:41] offset:0 sc1
  s_branch L_ad_q
L_aw_q:
  global_load_dword v4, v39, s[40:41] offset:0 sc1
  s_waitcnt vmcnt(0)
  v_readfirstlane_b32 s57, v4
  s_nop 3
  s_cmp_lg_u32 s57, 0
  s_cbranch_scc1 L_ad_q
  s_sub_u32 s50, s50, 1
  s_cmp_eq_u32 s50, 0
  s_cbranch_scc1 L_ad_q
  s_sleep 2
  s_branch L_aw_q
L_ad_q:
  s_mov_b64 exec, -1
  s_lshl_b32 s49, s42, 13
  s_add_u32 s49, s49, 786432
  v_lshlrev_b32 v28, 5, v1
  v_add_u32 v28, s49, v28
  v_add_u32 v29, 4096, v28
  global_load_dwordx4 v[64:67], v28, s[40:41] offset:0 sc1
  global_load_dwordx4 v[68:71], v28, s[40:41] offset:16 sc1
  global_load_dwordx4 v[72:75], v28, s[40:41] offset:2048 sc1
  global_load_dwordx4 v[76:79], v28, s[40:41] offset:2064 sc1
  global_load_dwordx4 v[80:83], v29, s[40:41] offset:0 sc1
  global_load_dwordx4 v[84:87], v29, s[40:41] offset:16 sc1
  global_load_dwordx4 v[88:91], v29, s[40:41] offset:2048 sc1
  global_load_dwordx4 v[92:95], v29, s[40:41] offset:2064 sc1
  v_add_u32 v28, 160768, v2
  s_waitcnt vmcnt(0)
  v_add_f32 v64, v64, v72
  v_add_f32 v80, v80, v88
  v_add_f32 v65, v65, v73
  v_add_f32 v81, v81, v89
  v_add_f32 v66, v66, v74
  v_add_f32 v82, v82, v90
  v_add_f32 v67, v67, v75
  v_add_f32 v83, v83, v91
  v_add_f32 v68, v68, v76
  v_add_f32 v84, v84, v92
  v_add_f32 v69, v69, v77
  v_add_f32 v85, v85, v93
  v_add_f32 v70, v70, v78
  v_add_f32 v86, v86, v94
  v_add_f32 v71, v71, v79
  v_add_f32 v87, v87, v95
  v_add_f32 v64, v64, v80
  v_add_f32 v65, v65, v81
  v_add_f32 v66, v66, v82
  v_add_f32 v67, v67, v83
  v_add_f32 v68, v68, v84
  v_add_f32 v69, v69, v85
  v_add_f32 v70, v70, v86
  v_add_f32 v71, v71, v87
  v_cvt_pk_bf16_f32 v32, v64, v65
  v_cvt_pk_bf16_f32 v33, v66, v67
  v_cvt_pk_bf16_f32 v34, v68, v69
  v_cvt_pk_bf16_f32 v35, v70, v71
  ds_write_b128 v28, v[32:35]
  s_waitcnt lgkmcnt(0)
  s_barrier
  s_mov_b32 s59, 0x3fb8aa3b
  s_mov_b32 s52, s28
  s_and_b32 s53, s29, 0xffff
  s_mov_b32 s54, 3584
  s_mov_b32 s55, 0x20000
  s_mov_b32 m0, 147456
  s_nop 0
  buffer_load_dwordx4 v2, s[52:55], 0 offen offset:0 lds
  buffer_load_dwordx4 v2, s[52:55], 0 offen offset:1024 lds
  buffer_load_dwordx4 v2, s[52:55], 0 offen offset:2048 lds
  buffer_load_dwordx4 v2, s[52:55], 0 offen offset:3072 lds
  s_mov_b32 s52, s30
  s_and_b32 s53, s31, 0xffff
  s_mov_b32 s54, 3584
  s_mov_b32 s55, 0x20000
  s_mov_b32 m0, 151552
  s_nop 0
  buffer_load_dwordx4 v2, s[52:55], 0 offen offset:0 lds
  buffer_load_dwordx4 v2, s[52:55], 0 offen offset:1024 lds
  buffer_load_dwordx4 v2, s[52:55], 0 offen offset:2048 lds
  buffer_load_dwordx4 v2, s[52:55], 0 offen offset:3072 lds
  s_mov_b32 s52, s32
  s_and_b32 s53, s33, 0xffff
  s_mov_b32 s54, 3584
  s_mov_b32 s55, 0x20000
  s_mov_b32 m0, 155648
  s_nop 0
  buffer_load_dwordx4 v2, s[52:55], 0 offen offset:0 lds
  buffer_load_dwordx4 v2, s[52:55], 0 offen offset:1024 lds
  buffer_load_dwordx4 v2, s[52:55], 0 offen offset:2048 lds
  buffer_load_dwordx4 v2, s[52:55], 0 offen offset:3072 lds
  s_lshl_b32 s49, s60, 7
  v_lshlrev_b32 v43, 1, v1
  v_add_u32 v43, s49, v43
  global_load_ushort v40, v43, s[16:17]
  v_mov_b32 v29, 0
  global_load_ushort v41, v29, s[34:35]
  v_add_f32 v16, v8, v9
  v_add_f32 v17, v10, v11
  v_add_f32 v18, v12, v13
  v_add_f32 v19, v14, v15
  v_add_f32 v16, v16, v17
  v_add_f32 v18, v18, v19
  v_add_f32 v16, v16, v18
  s_nop 1
  v_add_f32_dpp v16, v16, v16 row_ror:1 row_mask:0xf bank_mask:0xf
  s_nop 1
  v_add_f32_dpp v16, v16, v16 row_ror:2 row_mask:0xf bank_mask:0xf
  s_nop 1
  v_add_f32_dpp v16, v16, v16 row_ror:4 row_mask:0xf bank_mask:0xf
  s_nop 1
  v_add_f32_dpp v16, v16, v16 row_ror:8 row_mask:0xf bank_mask:0xf
  v_mov_b32 v17, v16
  s_nop 1
  v_permlane16_swap_b32 v16, v17
  s_nop 1
  v_add_f32 v16, v16, v17
  v_mov_b32 v17, v16
  s_nop 1
  v_permlane32_swap_b32 v16, v17
  s_nop 1
  v_add_f32 v16, v16, v17
  v_mul_f32 v16, 0x3b000000, v16
  v_sub_f32 v18, v8, v16
  v_mul_f32 v17, v18, v18
  v_sub_f32 v18, v9, v16
  v_fmac_f32 v17, v18, v18
  v_sub_f32 v18, v10, v16
  v_fmac_f32 v17, v18, v18
  v_sub_f32 v18, v11, v16
  v_fmac_f32 v17, v18, v18
  v_sub_f32 v18, v12, v16
  v_fmac_f32 v17, v18, v18
  v_sub_f32 v18, v13, v16
  v_fmac_f32 v17, v18, v18
  v_sub_f32 v18, v14, v16
  v_fmac_f32 v17, v18, v18
  v_sub_f32 v18, v15, v16
  v_fmac_f32 v17, v18, v18
  s_nop 1
  v_add_f32_dpp v17, v17, v17 row_ror:1 row_mask:0xf bank_mask:0xf
  s_nop 1
  v_add_f32_dpp v17, v17, v17 row_ror:2 row_mask:0xf bank_mask:0xf
  s_nop 1
  v_add_f32_dpp v17, v17, v17 row_ror:4 row_mask:0xf bank_mask:0xf
  s_nop 1
  v_add_f32_dpp v17, v17, v17 row_ror:8 row_mask:0xf bank_mask:0xf
  v_mov_b32 v18, v17
  s_nop 1
  v_permlane16_swap_b32 v17, v18
  s_nop 1
  v_add_f32 v17, v17, v18
  v_mov_b32 v18, v17
  s_nop 1
  v_permlane32_swap_b32 v17, v18
  s_nop 1
  v_add_f32 v17, v17, v18
  v_mul_f32 v17, 0x3b000000, v17
  v_cvt_pk_bf16_f32 v16, v16, v16
  v_lshlrev_b32 v16, 16, v16
  v_cvt_pk_bf16_f32 v17, v17, v17
  v_lshlrev_b32 v17, 16, v17
  v_add_f32 v17, 0x3727c5ac, v17
  v_cvt_pk_bf16_f32 v17, v17, v17
  v_lshlrev_b32 v17, 16, v17
  v_sqrt_f32 v18, v17
  v_rsq_f32 v19, v17
  s_nop 0
  v_fma_f32 v20, -v18, v18, v17
  v_mul_f32 v19, 0.5, v19
  v_fmac_f32 v18, v20, v19
  v_cvt_pk_bf16_f32 v18, v18, v18
  v_lshlrev_b32 v18, 16, v18
  v_rcp_f32 v19, v18
  v_sub_f32 v8, v8, v16
  v_sub_f32 v9, v9, v16
  v_sub_f32 v10, v10, v16
  v_sub_f32 v11, v11, v16
  v_sub_f32 v12, v12, v16
  v_sub_f32 v13, v13, v16
  v_sub_f32 v14, v14, v16
  v_sub_f32 v15, v15, v16
  v_cvt_pk_bf16_f32 v8, v8, v8
  v_lshlrev_b32 v8, 16, v8
  v_cvt_pk_bf16_f32 v9, v9, v9
  v_lshlrev_b32 v9, 16, v9
  v_cvt_pk_bf16_f32 v10, v10, v10
  v_lshlrev_b32 v10, 16, v10
  v_cvt_pk_bf16_f32 v11, v11, v11
  v_lshlrev_b32 v11, 16, v11
  v_cvt_pk_bf16_f32 v12, v12, v12
  v_lshlrev_b32 v12, 16, v12
  v_cvt_pk_bf16_f32 v13, v13, v13
  v_lshlrev_b32 v13, 16, v13
  v_cvt_pk_bf16_f32 v14, v14, v14
  v_lshlrev_b32 v14, 16, v14
  v_cvt_pk_bf16_f32 v15, v15, v15
  v_lshlrev_b32 v15, 16, v15
  v_mul_f32 v20, v8, v19
  v_fma_f32 v21, -v20, v18, v8
  v_fma_f32 v8, v21, v19, v20
  v_mul_f32 v20, v9, v19
  v_fma_f32 v21, -v20, v18, v9
  v_fma_f32 v9, v21, v19, v20
  v_mul_f32 v20, v10, v19
  v_fma_f32 v21, -v20, v18, v10
  v_fma_f32 v10, v21, v19, v20
  v_mul_f32 v20, v11, v19
  v_fma_f32 v21, -v20, v18, v11
  v_fma_f32 v11, v21, v19, v20
  v_mul_f32 v20, v12, v19
  v_fma_f32 v21, -v20, v18, v12
  v_fma_f32 v12, v21, v19, v20
  v_mul_f32 v20, v13, v19
  v_fma_f32 v21, -v20, v18, v13
  v_fma_f32 v13, v21, v19, v20
  v_mul_f32 v20, v14, v19
  v_fma_f32 v21, -v20, v18, v14
  v_fma_f32 v14, v21, v19, v20
  v_mul_f32 v20, v15, v19
  v_fma_f32 v21, -v20, v18, v15
  v_fma_f32 v15, v21, v19, v20
  v_cvt_pk_bf16_f32 v24, v8, v9
  v_cvt_pk_bf16_f32 v25, v10, v11
  v_cvt_pk_bf16_f32 v26, v12, v13
  v_cvt_pk_bf16_f32 v27, v14, v15
  v_lshlrev_b32 v8, 16, v24
  v_and_b32 v9, 0xffff0000, v24
  v_lshlrev_b32 v10, 16, v25
  v_and_b32 v11, 0xffff0000, v25
  v_lshlrev_b32 v12, 16, v26
  v_and_b32 v13, 0xffff0000, v26
  v_lshlrev_b32 v14, 16, v27
  v_and_b32 v15, 0xffff0000, v27
  v_add_u32 v28, 159744, v2
  ds_write_b128 v28, v[24:27]
  v_mov_b32 v28, s51
  v_add_u32 v28, 159744, v28
  s_waitcnt lgkmcnt(0)
  ds_read_b32 v42, v28
  v_lshrrev_b32 v29, 4, v1
  v_bfe_u32 v57, v1, 2, 2
  v_lshl_add_u32 v57, v29, 3, v57
  v_lshlrev_b32 v57, 7, v57
  v_and_b32 v28, 3, v1
  v_lshl_add_u32 v57, v28, 3, v57
  v_add_u32 v57, 131072, v57
  s_waitcnt vmcnt(0) lgkmcnt(0)
  v_lshlrev_b32 v44, 16, v42
  v_and_b32 v45, 0xffff0000, v42
  v_mov_b32 v46, 0
  v_mov_b32 v47, 0
  v_lshlrev_b32 v28, 2, v1
  v_add_u32 v28, 147456, v28
  s_mov_b32 s57, 14
  s_mov_b32 s58, 0xc0135761
  s_mov_b32 s56, 0xbdd2d3e8
L_gate:
  ds_read_b32 v48, v28
  ds_read_b32 v49, v28 offset:4096
  ds_read_b32 v50, v28 offset:8192
  v_add_u32 v28, 256, v28
  s_waitcnt lgkmcnt(0)
  v_lshlrev_b32 v51, 16, v48
  v_and_b32 v52, 0xffff0000, v48
  v_lshlrev_b32 v53, 16, v49
  v_and_b32 v54, 0xffff0000, v49
  v_lshlrev_b32 v55, 16, v50
  v_and_b32 v56, 0xffff0000, v50
  v_mul_f32 v8, v44, v51
  v_mul_f32 v9, v44, v52
  v_mul_f32 v10, v45, v51
  v_mul_f32 v11, v45, v52
  v_cvt_pk_bf16_f32 v8, v8, v8
  v_lshlrev_b32 v8, 16, v8
  v_cvt_pk_bf16_f32 v9, v9, v9
  v_lshlrev_b32 v9, 16, v9
  v_cvt_pk_bf16_f32 v10, v10, v10
  v_lshlrev_b32 v10, 16, v10
  v_cvt_pk_bf16_f32 v11, v11, v11
  v_lshlrev_b32 v11, 16, v11
  v_add_f32 v8, v8, v53
  v_add_f32 v9, v9, v54
  v_add_f32 v10, v10, v53
  v_add_f32 v11, v11, v54
  v_cvt_pk_bf16_f32 v8, v8, v8
  v_lshlrev_b32 v8, 16, v8
  v_cvt_pk_bf16_f32 v9, v9, v9
  v_lshlrev_b32 v9, 16, v9
  v_cvt_pk_bf16_f32 v10, v10, v10
  v_lshlrev_b32 v10, 16, v10
  v_cvt_pk_bf16_f32 v11, v11, v11
  v_lshlrev_b32 v11, 16, v11
  v_mul_f32 v12, v8, v8
  v_mul_f32 v13, v9, v9
  v_mul_f32 v14, v10, v10
  v_mul_f32 v15, v11, v11
  v_mul_f32 v12, s56, v12
  v_mul_f32 v13, s56, v13
  v_mul_f32 v14, s56, v14
  v_mul_f32 v15, s56, v15
  v_add_f32 v12, s58, v12
  v_add_f32 v13, s58, v13
  v_add_f32 v14, s58, v14
  v_add_f32 v15, s58, v15
  v_mul_f32 v12, v12, v8
  v_mul_f32 v13, v13, v9
  v_mul_f32 v14, v14, v10
  v_mul_f32 v15, v15, v11
  v_exp_f32 v12, v12
  v_exp_f32 v13, v13
  v_exp_f32 v14, v14
  v_exp_f32 v15, v15
  s_nop 0
  v_add_f32 v12, 1.0, v12
  v_add_f32 v13, 1.0, v13
  v_add_f32 v14, 1.0, v14
  v_add_f32 v15, 1.0, v15
  v_rcp_f32 v12, v12
  v_rcp_f32 v13, v13
  v_rcp_f32 v14, v14
  v_rcp_f32 v15, v15
  s_nop 0
  v_mul_f32 v8, v8, v12
  v_mul_f32 v9, v9, v13
  v_mul_f32 v10, v10, v14
  v_mul_f32 v11, v11, v15
  v_cvt_pk_bf16_f32 v8, v8, v8
  v_lshlrev_b32 v8, 16, v8
  v_cvt_pk_bf16_f32 v9, v9, v9
  v_lshlrev_b32 v9, 16, v9
  v_cvt_pk_bf16_f32 v10, v10, v10
  v_lshlrev_b32 v10, 16, v10
  v_cvt_pk_bf16_f32 v11, v11, v11
  v_lshlrev_b32 v11, 16, v11
  v_fmac_f32 v46, v8, v55
  v_fmac_f32 v46, v9, v56
  v_fmac_f32 v47, v10, v55
  v_fmac_f32 v47, v11, v56
  s_sub_u32 s57, s57, 1
  s_cmp_lg_u32 s57, 0
  s_cbranch_scc1 L_gate
  s_waitcnt vmcnt(0)
  s_nop 1
  v_add_f32_dpp v46, v46, v46 row_ror:1 row_mask:0xf bank_mask:0xf
  s_nop 1
  v_add_f32_dpp v46, v46, v46 row_ror:2 row_mask:0xf bank_mask:0xf
  s_nop 1
  v_add_f32_dpp v46, v46, v46 row_ror:4 row_mask:0xf bank_mask:0xf
  s_nop 1
  v_add_f32_dpp v46, v46, v46 row_ror:8 row_mask:0xf bank_mask:0xf
  v_mov_b32 v16, v46
  s_nop 1
  v_permlane16_swap_b32 v46, v16
  s_nop 1
  v_add_f32 v46, v46, v16
  v_mov_b32 v16, v46
  s_nop 1
  v_permlane32_swap_b32 v46, v16
  s_nop 1
  v_add_f32 v46, v46, v16
  s_nop 1
  v_add_f32_dpp v47, v47, v47 row_ror:1 row_mask:0xf bank_mask:0xf
  s_nop 1
  v_add_f32_dpp v47, v47, v47 row_ror:2 row_mask:0xf bank_mask:0xf
  s_nop 1
  v_add_f32_dpp v47, v47, v47 row_ror:4 row_mask:0xf bank_mask:0xf
  s_nop 1
  v_add_f32_dpp v47, v47, v47 row_ror:8 row_mask:0xf bank_mask:0xf
  v_mov_b32 v16, v47
  s_nop 1
  v_permlane16_swap_b32 v47, v16
  s_nop 1
  v_add_f32 v47, v47, v16
  v_mov_b32 v16, v47
  s_nop 1
  v_permlane32_swap_b32 v47, v16
  s_nop 1
  v_add_f32 v47, v47, v16
  v_lshlrev_b32 v41, 16, v41
  v_cvt_pk_bf16_f32 v46, v46, v46
  v_lshlrev_b32 v46, 16, v46
  v_add_f32 v46, v46, v41
  v_cvt_pk_bf16_f32 v46, v46, v46
  v_lshlrev_b32 v46, 16, v46
  v_mul_f32 v16, s59, v46
  v_exp_f32 v16, -v16
  s_nop 0
  v_add_f32 v16, 1.0, v16
  v_rcp_f32 v17, v16
  s_nop 0
  v_mul_f32 v18, v46, v17
  v_fma_f32 v19, -v18, v16, v46
  v_fma_f32 v19, v19, v17, v18
  v_cmp_gt_f32 vcc, 0x7f000000, v16
  s_nop 1
  v_cndmask_b32 v46, v18, v19, vcc
  v_cvt_pk_bf16_f32 v46, v46, v46
  v_lshlrev_b32 v46, 16, v46
  v_cvt_pk_bf16_f32 v47, v47, v47
  v_lshlrev_b32 v47, 16, v47
  v_add_f32 v47, v47, v41
  v_cvt_pk_bf16_f32 v47, v47, v47
  v_lshlrev_b32 v47, 16, v47
  v_mul_f32 v16, s59, v47
  v_exp_f32 v16, -v16
  s_nop 0
  v_add_f32 v16, 1.0, v16
  v_rcp_f32 v17, v16
  s_nop 0
  v_mul_f32 v18, v47, v17
  v_fma_f32 v19, -v18, v16, v47
  v_fma_f32 v19, v19, v17, v18
  v_cmp_gt_f32 vcc, 0x7f000000, v16
  s_nop 1
  v_cndmask_b32 v47, v18, v19, vcc
  v_cvt_pk_bf16_f32 v47, v47, v47
  v_lshlrev_b32 v47, 16, v47
  v_bfrev_b32 v16, 1
  v_cmp_eq_u32 vcc, 0, v46
  v_cmp_eq_u32 s[52:53], 0, v47
  s_nop 1
  v_cndmask_b32 v46, v46, v16, vcc
  v_cndmask_b32 v47, v47, v16, s[52:53]
  s_lshl_b32 s49, s51, 1
  s_add_u32 s49, s49, 49152
  v_mov_b32 v28, s49
  s_mov_b64 exec, 1
  global_store_dwordx2 v28, v[46:47], s[40:41] sc1
  s_mov_b64 exec, -1
  v_lshlrev_b32 v28, 5, v1
  s_mov_b32 s50, 400000
  s_mov_b64 exec, 0xff
L_allw:
  global_load_dword v4, v28, s[38:39] sc1
  s_waitcnt vmcnt(0)
  v_cmp_le_u32 vcc, 32, v4
  s_nop 1
  s_cmp_eq_u64 vcc, exec
  s_cbranch_scc1 L_alld
  s_sub_u32 s50, s50, 1
  s_cmp_eq_u32 s50, 0
  s_cbranch_scc1 L_alld
  s_sleep 32
  s_branch L_allw
L_alld:
  s_mov_b64 exec, -1
  v_mov_b32 v28, 161920
  v_and_b32 v29, 3, v1
  v_lshlrev_b32 v29, 2, v29
  v_add_u32 v29, 161792, v29
  s_mov_b32 s50, 8000000
L_mlw:
  ds_read_b128 v[4:7], v28
  ds_read_b32 v8, v29 offset:0
  ds_read_b32 v12, v29 offset:16
  ds_read_b32 v9, v29 offset:32
  ds_read_b32 v13, v29 offset:48
  ds_read_b32 v10, v29 offset:64
  ds_read_b32 v14, v29 offset:80
  ds_read_b32 v11, v29 offset:96
  ds_read_b32 v15, v29 offset:112
  s_waitcnt lgkmcnt(0)
  v_and_b32 v4, v4, v5
  v_and_b32 v6, v6, v7
  v_and_b32 v4, v4, v6
  s_nop 0
  v_readfirstlane_b32 s57, v4
  s_nop 3
  s_cmp_lg_u32 s57, 0
  s_cbranch_scc1 L_mld
  s_sub_u32 s50, s50, 1
  s_cmp_eq_u32 s50, 0
  s_cbranch_scc1 L_mld
  s_sleep 8
  s_branch L_mlw
L_mld:
  v_max3_f32 v16, v8, v9, v10
  v_max_f32 v16, v16, v11
  v_sub_f32 v8, v8, v16
  v_sub_f32 v9, v9, v16
  v_sub_f32 v10, v10, v16
  v_sub_f32 v11, v11, v16
  v_mul_f32 v8, s59, v8
  v_mul_f32 v9, s59, v9
  v_mul_f32 v10, s59, v10
  v_mul_f32 v11, s59, v11
  v_exp_f32 v8, v8
  v_exp_f32 v9, v9
  v_exp_f32 v10, v10
  v_exp_f32 v11, v11
  s_nop 0
  v_mul_f32 v17, v8, v12
  v_fmac_f32 v17, v9, v13
  v_fmac_f32 v17, v10, v14
  v_fmac_f32 v17, v11, v15
  s_lshl_b32 s49, s47, 5
  s_add_u32 s49, s49, 8192
  v_lshlrev_b32 v28, 3, v1
  v_add_u32 v28, s49, v28
  v_mov_b32 v30, 1
  s_mov_b64 exec, 15
  global_store_dwordx2 v28, v[16:17], s[40:41] sc1
  s_mov_b64 exec, -1
  s_lshl_b32 s49, s42, 9
  s_add_u32 s49, s49, 32768
  v_mov_b32 v51, s49
  s_waitcnt vmcnt(0)
  s_mov_b64 exec, 1
  global_atomic_add v4, v51, v30, s[40:41] sc0 sc1
  s_mov_b32 s50, 400000
  s_waitcnt vmcnt(0)
  v_readfirstlane_b32 s57, v4
  s_nop 3
  s_and_b32 s57, s57, 31
  s_cmp_lg_u32 s57, 31
  s_cbranch_scc1 L_aw_ml
  s_mov_b32 exec_lo, -1
  global_store_dword v38, v30, s[40:41] offset:4 sc1
  s_branch L_ad_ml
L_aw_ml:
  global_load_dword v4, v39, s[40:41] offset:4 sc1
  s_waitcnt vmcnt(0)
  v_readfirstlane_b32 s57, v4
  s_nop 3
  s_cmp_lg_u32 s57, 0
  s_cbranch_scc1 L_ad_ml
  s_sub_u32 s50, s50, 1
  s_cmp_eq_u32 s50, 0
  s_cbranch_scc1 L_ad_ml
  s_sleep 16
  s_branch L_aw_ml
L_ad_ml:
  s_mov_b64 exec, -1
  s_lshl_b32 s49, s42, 10
  s_add_u32 s49, s49, 8192
  v_lshlrev_b32 v28, 3, v1
  v_add_u32 v28, s49, v28
  global_load_dwordx2 v[8:9], v28, s[40:41] sc1
  global_load_dwordx2 v[10:11], v28, s[40:41] offset:512 sc1
  s_waitcnt vmcnt(0)
  v_max_f32 v16, v8, v10
  s_nop 1
  v_max_f32_dpp v16, v16, v16 row_ror:4 row_mask:0xf bank_mask:0xf
  s_nop 1
  v_max_f32_dpp v16, v16, v16 row_ror:8 row_mask:0xf bank_mask:0xf
  v_mov_b32 v17, v16
  s_nop 1
  v_permlane16_swap_b32 v16, v17
  s_nop 1
  v_max_f32 v16, v16, v17
  v_mov_b32 v17, v16
  s_nop 1
  v_permlane32_swap_b32 v16, v17
  s_nop 1
  v_max_f32 v16, v16, v17
  v_sub_f32 v8, v8, v16
  v_sub_f32 v10, v10, v16
  v_mul_f32 v8, s59, v8
  v_mul_f32 v10, s59, v10
  v_exp_f32 v8, v8
  v_exp_f32 v10, v10
  s_nop 0
  v_mul_f32 v17, v8, v9
  v_fmac_f32 v17, v10, v11
  s_nop 1
  v_add_f32_dpp v17, v17, v17 row_ror:4 row_mask:0xf bank_mask:0xf
  s_nop 1
  v_add_f32_dpp v17, v17, v17 row_ror:8 row_mask:0xf bank_mask:0xf
  v_mov_b32 v18, v17
  s_nop 1
  v_permlane16_swap_b32 v17, v18
  s_nop 1
  v_add_f32 v17, v17, v18
  v_mov_b32 v18, v17
  s_nop 1
  v_permlane32_swap_b32 v17, v18
  s_nop 1
  v_add_f32 v17, v17, v18
  v_rcp_f32 v18, v17
  s_nop 0
  v_fma_f32 v19, -v17, v18, 1.0
  v_fmac_f32 v18, v19, v18
  v_lshlrev_b32 v28, 2, v1
  v_add_u32 v28, 161952, v28
  v_mov_b32 v29, 161984
  s_mov_b64 exec, 15
  ds_write_b32 v28, v16
  ds_write_b32 v28, v18 offset:16
  s_waitcnt lgkmcnt(0)
  s_mov_b64 exec, 1
  ds_write_b32 v29, v30
  s_mov_b64 exec, -1
  v_lshrrev_b32 v59, 2, v1
  v_lshlrev_b32 v59, 7, v59
  v_and_b32 v60, 3, v1
  v_lshl_add_u32 v59, v60, 4, v59
  s_lshl_b32 s49, s42, 12
  s_add_u32 s49, s49, 851968
  v_add_u32 v59, s49, v59
  v_mov_b32 v60, 1
  v_mov_b32 v61, 1
  v_mov_b32 v62, 1
  v_mov_b32 v63, 1
  v_lshrrev_b32 v33, 4, v1
  v_and_b32 v34, 15, v1
  v_and_b32 v28, 7, v1
  v_lshl_add_u32 v28, v33, 3, v28
  v_lshrrev_b32 v29, 3, v34
  v_lshl_add_u32 v28, v29, 8, v28
  v_lshlrev_b32 v29, 2, v28
  v_add_u32 v29, 147456, v29
  v_cmp_eq_u32 s[68:69], 8, v34
  v_cmp_eq_u32 s[70:71], 7, v34
  v_min_u32 v35, 8, v34
  v_subrev_u32 v36, 8, v34
  s_nop 0
  v_cndmask_b32 v36, v36, 8, s[70:71]
  v_lshlrev_b32 v37, 6, v33
  s_lshl_b32 s49, s42, 12
  s_add_u32 s49, s49, 917504
  v_lshl_add_u32 v32, v35, 2, v37
  v_add_u32 v32, s49, v32
  v_lshl_add_u32 v48, v36, 2, v37
  v_add_u32 v48, s49, v48
  v_add_u32 v48, 2048, v48
  v_and_b32 v31, 3, v1
  v_lshl_add_u32 v31, v31, 4, v37
  s_lshl_b32 s56, s61, 10
  s_add_u32 s49, s49, s56
  v_add_u32 v31, s49, v31
  s_lshl_b32 s49, s60, 9
  s_add_u32 s49, s49, 40960
  v_lshlrev_b32 v37, 7, v33
  v_lshl_add_u32 v49, v35, 2, v37
  v_add_u32 v49, s49, v49
  v_lshl_add_u32 v50, v36, 2, v37
  v_add_u32 v50, s49, v50
  v_cmp_eq_u32 s[52:53], 1, v33
  v_cmp_eq_u32 s[54:55], 2, v33
  v_cmp_eq_u32 s[44:45], 3, v33
  v_cmp_gt_u32 s[72:73], 8, v34
  s_lshl_b32 s49, s60, 8
  s_add_u32 s49, s49, 49152
  v_lshlrev_b32 v36, 2, v1
  v_add_u32 v36, s49, v36
  s_mov_b32 s50, 400000
L_gw:
  global_load_dword v41, v36, s[40:41] sc1
  s_waitcnt vmcnt(0)
  v_cmp_eq_u32 vcc, 0, v41
  s_nop 1
  s_cmp_eq_u64 vcc, 0
  s_cbranch_scc1 L_gd
  s_sub_u32 s50, s50, 1
  s_cmp_eq_u32 s50, 0
  s_cbranch_scc1 L_gd
  s_sleep 16
  s_branch L_gw
L_gd:
  v_lshlrev_b32 v40, 16, v40
  s_waitcnt vmcnt(0) lgkmcnt(0)
  v_mov_b32 v28, 161988
  s_mov_b32 s50, 8000000
L_wow:
  ds_read_b32 v4, v28
  s_waitcnt lgkmcnt(0)
  v_readfirstlane_b32 s57, v4
  s_nop 3
  s_cmp_lg_u32 s57, 0
  s_cbranch_scc1 L_wod
  s_sub_u32 s50, s50, 1
  s_cmp_eq_u32 s50, 0
  s_cbranch_scc1 L_wod
  s_sleep 4
  s_branch L_wow
L_wod:
  s_mov_b64 s[76:77], s[52:53]
  s_mov_b64 s[78:79], s[54:55]
  v_mov_b32 v58, v29
  s_mov_b32 s52, s24
  s_and_b32 s53, s25, 0xffff
  s_mov_b32 s54, 4194304
  s_mov_b32 s55, 0x20000
  v_lshrrev_b32 v28, 3, v1
  v_lshlrev_b32 v28, 10, v28
  v_and_b32 v29, 7, v1
  v_lshl_or_b32 v28, v29, 4, v28
  s_lshl_b32 s56, s42, 19
  s_lshl_b32 s49, s61, 17
  s_add_u32 s56, s56, s49
  s_lshl_b32 s49, s60, 7
  s_add_u32 s56, s56, s49
  s_mov_b32 m0, 131072
  s_nop 0
  buffer_load_dwordx4 v28, s[52:55], s56 offen nt lds
  s_add_u32 s56, s56, 8192
  s_mov_b32 m0, 132096
  s_nop 0
  buffer_load_dwordx4 v28, s[52:55], s56 offen nt lds
  s_add_u32 s56, s56, 8192
  s_mov_b32 m0, 133120
  s_nop 0
  buffer_load_dwordx4 v28, s[52:55], s56 offen nt lds
  s_add_u32 s56, s56, 8192
  s_mov_b32 m0, 134144
  s_nop 0
  buffer_load_dwordx4 v28, s[52:55], s56 offen nt lds
  s_add_u32 s56, s56, 8192
  s_mov_b32 m0, 135168
  s_nop 0
  buffer_load_dwordx4 v28, s[52:55], s56 offen nt lds
  s_add_u32 s56, s56, 8192
  s_mov_b32 m0, 136192
  s_nop 0
  buffer_load_dwordx4 v28, s[52:55], s56 offen nt lds
  s_add_u32 s56, s56, 8192
  s_mov_b32 m0, 137216
  s_nop 0
  buffer_load_dwordx4 v28, s[52:55], s56 offen nt lds
  s_add_u32 s56, s56, 8192
  s_mov_b32 m0, 138240
  s_nop 0
  buffer_load_dwordx4 v28, s[52:55], s56 offen nt lds
  s_add_u32 s56, s56, 8192
  s_mov_b32 m0, 139264
  s_nop 0
  buffer_load_dwordx4 v28, s[52:55], s56 offen nt lds
  s_add_u32 s56, s56, 8192
  s_mov_b32 m0, 140288
  s_nop 0
  buffer_load_dwordx4 v28, s[52:55], s56 offen nt lds
  s_add_u32 s56, s56, 8192
  s_mov_b32 m0, 141312
  s_nop 0
  buffer_load_dwordx4 v28, s[52:55], s56 offen nt lds
  s_add_u32 s56, s56, 8192
  s_mov_b32 m0, 142336
  s_nop 0
  buffer_load_dwordx4 v28, s[52:55], s56 offen nt lds
  s_add_u32 s56, s56, 8192
  s_mov_b32 m0, 143360
  s_nop 0
  buffer_load_dwordx4 v28, s[52:55], s56 offen nt lds
  s_add_u32 s56, s56, 8192
  s_mov_b32 m0, 144384
  s_nop 0
  buffer_load_dwordx4 v28, s[52:55], s56 offen nt lds
  s_add_u32 s56, s56, 8192
  s_mov_b32 m0, 145408
  s_nop 0
  buffer_load_dwordx4 v28, s[52:55], s56 offen nt lds
  s_add_u32 s56, s56, 8192
  s_mov_b32 m0, 146432
  s_nop 0
  buffer_load_dwordx4 v28, s[52:55], s56 offen nt lds
  s_add_u32 s56, s56, 8192
  v_mov_b32 v29, v58
  s_mov_b64 s[52:53], s[76:77]
  s_mov_b64 s[54:55], s[78:79]
  v_mov_b32 v28, 161992
  s_lshl_b32 s49, s42, 9
  s_add_u32 s49, s49, 32772
  s_mov_b32 s58, 1
  s_mov_b32 s50, 8000000
L_prw:
  ds_read_b32 v4, v28
  s_waitcnt lgkmcnt(0)
  v_readfirstlane_b32 s57, v4
  s_nop 3
  s_cmp_ge_u32 s57, 4
  s_cbranch_scc1 L_prd
  s_sub_u32 s50, s50, 1
  s_cmp_eq_u32 s50, 0
  s_cbranch_scc1 L_prd
  s_sleep 1
  s_branch L_prw
L_prd:
  s_atomic_add s58, s[40:41], s49 glc
  s_waitcnt lgkmcnt(0)
  s_and_b32 s58, s58, 31
  s_cmp_lg_u32 s58, 31
  s_cbranch_scc1 L_nogo
  s_mov_b32 exec_hi, 0
  global_store_dword v38, v30, s[40:41] offset:8 sc1
  s_mov_b64 exec, -1
L_nogo:
  s_barrier
  s_waitcnt vmcnt(0)
  ds_read_b64_tr_b16 v[128:129], v57 offset:0
  ds_read_b64_tr_b16 v[130:131], v57 offset:512
  ds_read_b64_tr_b16 v[132:133], v57 offset:32
  ds_read_b64_tr_b16 v[134:135], v57 offset:544
  ds_read_b64_tr_b16 v[136:137], v57 offset:64
  ds_read_b64_tr_b16 v[138:139], v57 offset:576
  ds_read_b64_tr_b16 v[140:141], v57 offset:96
  ds_read_b64_tr_b16 v[142:143], v57 offset:608
  ds_read_b64_tr_b16 v[144:145], v57 offset:4096
  ds_read_b64_tr_b16 v[146:147], v57 offset:4608
  ds_read_b64_tr_b16 v[148:149], v57 offset:4128
  ds_read_b64_tr_b16 v[150:151], v57 offset:4640
  ds_read_b64_tr_b16 v[152:153], v57 offset:4160
  ds_read_b64_tr_b16 v[154:155], v57 offset:4672
  ds_read_b64_tr_b16 v[156:157], v57 offset:4192
  ds_read_b64_tr_b16 v[158:159], v57 offset:4704
  ds_read_b64_tr_b16 v[160:161], v57 offset:8192
  ds_read_b64_tr_b16 v[162:163], v57 offset:8704
  ds_read_b64_tr_b16 v[164:165], v57 offset:8224
  ds_read_b64_tr_b16 v[166:167], v57 offset:8736
  ds_read_b64_tr_b16 v[168:169], v57 offset:8256
  ds_read_b64_tr_b16 v[170:171], v57 offset:8768
  ds_read_b64_tr_b16 v[172:173], v57 offset:8288
  ds_read_b64_tr_b16 v[174:175], v57 offset:8800
  ds_read_b64_tr_b16 v[176:177], v57 offset:12288
  ds_read_b64_tr_b16 v[178:179], v57 offset:12800
  ds_read_b64_tr_b16 v[180:181], v57 offset:12320
  ds_read_b64_tr_b16 v[182:183], v57 offset:12832
  ds_read_b64_tr_b16 v[184:185], v57 offset:12352
  ds_read_b64_tr_b16 v[186:187], v57 offset:12864
  ds_read_b64_tr_b16 v[188:189], v57 offset:12384
  ds_read_b64_tr_b16 v[190:191], v57 offset:12896
  s_mov_b64 exec, 1
  s_mov_b32 s50, 400000
  s_cmp_eq_u32 s58, 31
  s_cbranch_scc1 L_ad_fin
L_aw_fin:
  global_load_dword v4, v39, s[40:41] offset:8 sc1
  s_waitcnt vmcnt(0)
  v_readfirstlane_b32 s57, v4
  s_nop 3
  s_cmp_lg_u32 s57, 0
  s_cbranch_scc1 L_ad_fin
  s_sub_u32 s50, s50, 1
  s_cmp_eq_u32 s50, 0
  s_cbranch_scc1 L_ad_fin
  s_sleep 1
  s_branch L_aw_fin
L_ad_fin:
  s_mov_b32 s56, 0x00040004
  s_mov_b32 s57, 0x00040004
  s_mov_b32 exec_lo, 0x00070007
  s_mov_b32 exec_hi, 0x00070007
  s_mov_b32 s50, 400000
L_ow:
  global_load_dwordx4 v[64:67], v31, s[40:41] offset:0 sc1
  global_load_dwordx4 v[68:71], v31, s[40:41] offset:256 sc1
  global_load_dwordx4 v[72:75], v31, s[40:41] offset:512 sc1
  global_load_dwordx4 v[76:79], v31, s[40:41] offset:768 sc1
  s_waitcnt vmcnt(0)
  v_min3_f32 v4, v64, v68, v72
  v_min_f32 v4, v4, v76
  v_cmp_eq_f32 vcc, 0x42000000, v4
  s_nop 1
  s_and_b64 vcc, vcc, s[56:57]
  s_cmp_eq_u64 vcc, s[56:57]
  s_cbranch_scc1 L_od
  s_sub_u32 s50, s50, 1
  s_cmp_eq_u32 s50, 0
  s_cbranch_scc1 L_od
  s_sleep 1
  s_branch L_ow
L_od:
  s_mov_b64 exec, -1
  v_cvt_pk_bf16_f32 v80, v64, v65
  v_cvt_pk_bf16_f32 v81, v66, v67
  v_cvt_pk_bf16_f32 v82, v68, v69
  v_cvt_pk_bf16_f32 v83, v70, v71
  v_cvt_pk_bf16_f32 v84, v72, v73
  v_cvt_pk_bf16_f32 v85, v74, v75
  v_cvt_pk_bf16_f32 v86, v76, v77
  v_cvt_pk_bf16_f32 v87, v78, v79
  s_nop 0
  v_mov_b32_dpp v112, v80 row_newbcast:0 row_mask:0xf bank_mask:0xf
  v_mov_b32_dpp v113, v81 row_newbcast:0 row_mask:0xf bank_mask:0xf
  v_mov_b32_dpp v114, v80 row_newbcast:1 row_mask:0xf bank_mask:0xf
  v_mov_b32_dpp v115, v81 row_newbcast:1 row_mask:0xf bank_mask:0xf
  v_mov_b32_dpp v116, v82 row_newbcast:0 row_mask:0xf bank_mask:0xf
  v_mov_b32_dpp v117, v83 row_newbcast:0 row_mask:0xf bank_mask:0xf
  v_mov_b32_dpp v118, v82 row_newbcast:1 row_mask:0xf bank_mask:0xf
  v_mov_b32_dpp v119, v83 row_newbcast:1 row_mask:0xf bank_mask:0xf
  v_mov_b32_dpp v120, v84 row_newbcast:0 row_mask:0xf bank_mask:0xf
  v_mov_b32_dpp v121, v85 row_newbcast:0 row_mask:0xf bank_mask:0xf
  v_mov_b32_dpp v122, v84 row_newbcast:1 row_mask:0xf bank_mask:0xf
  v_mov_b32_dpp v123, v85 row_newbcast:1 row_mask:0xf bank_mask:0xf
  v_mov_b32_dpp v124, v86 row_newbcast:0 row_mask:0xf bank_mask:0xf
  v_mov_b32_dpp v125, v87 row_newbcast:0 row_mask:0xf bank_mask:0xf
  v_mov_b32_dpp v126, v86 row_newbcast:1 row_mask:0xf bank_mask:0xf
  v_mov_b32_dpp v127, v87 row_newbcast:1 row_mask:0xf bank_mask:0xf
  s_waitcnt lgkmcnt(0)
  s_nop 1
  v_mfma_f32_16x16x32_bf16 v[8:11], v[112:115], v[128:131], 0
  v_mfma_f32_16x16x32_bf16 v[12:15], v[112:115], v[132:135], 0
  v_mfma_f32_16x16x32_bf16 v[16:19], v[112:115], v[136:139], 0
  v_mfma_f32_16x16x32_bf16 v[20:23], v[112:115], v[140:143], 0
  v_mfma_f32_16x16x32_bf16 v[8:11], v[116:119], v[144:147], v[8:11]
  v_mfma_f32_16x16x32_bf16 v[12:15], v[116:119], v[148:151], v[12:15]
  v_mfma_f32_16x16x32_bf16 v[16:19], v[116:119], v[152:155], v[16:19]
  v_mfma_f32_16x16x32_bf16 v[20:23], v[116:119], v[156:159], v[20:23]
  v_mfma_f32_16x16x32_bf16 v[8:11], v[120:123], v[160:163], v[8:11]
  v_mfma_f32_16x16x32_bf16 v[12:15], v[120:123], v[164:167], v[12:15]
  v_mfma_f32_16x16x32_bf16 v[16:19], v[120:123], v[168:171], v[16:19]
  v_mfma_f32_16x16x32_bf16 v[20:23], v[120:123], v[172:175], v[20:23]
  v_mfma_f32_16x16x32_bf16 v[8:11], v[124:127], v[176:179], v[8:11]
  v_mfma_f32_16x16x32_bf16 v[12:15], v[124:127], v[180:183], v[12:15]
  v_mfma_f32_16x16x32_bf16 v[16:19], v[124:127], v[184:187], v[16:19]
  v_mfma_f32_16x16x32_bf16 v[20:23], v[124:127], v[188:191], v[20:23]
  s_nop 5
  v_cndmask_b32 v8, v8, v12, s[52:53]
  v_cndmask_b32 v8, v8, v16, s[54:55]
  v_cndmask_b32 v8, v8, v20, s[44:45]
  v_cndmask_b32 v9, v8, 1.0, s[68:69]
  v_cndmask_b32 v10, v8, 1.0, s[70:71]
  s_mov_b32 exec_lo, 0x01ff01ff
  s_mov_b32 exec_hi, 0x01ff01ff
  global_atomic_add_f32 v12, v49, v9, s[40:41] sc0 sc1
  s_mov_b32 exec_lo, 0xff80ff80
  s_mov_b32 exec_hi, 0xff80ff80
  global_atomic_add_f32 v13, v50, v10, s[40:41] offset:64 sc0 sc1
  s_mov_b64 exec, -1
  s_waitcnt vmcnt(0)
  v_mov_b32_dpp v14, v12 row_newbcast:8 row_mask:0xf bank_mask:0xf
  v_mov_b32_dpp v15, v13 row_newbcast:7 row_mask:0xf bank_mask:0xf
  v_cndmask_b32 v12, v13, v12, s[72:73]
  v_cndmask_b32 v14, v15, v14, s[72:73]
  v_add_f32 v8, v8, v12
  v_cmp_eq_f32 vcc, 0x41f80000, v14
  v_cvt_pk_bf16_f32 v8, v8, v8
  v_lshlrev_b32 v8, 16, v8
  v_mul_f32 v8, v8, v41
  v_cvt_pk_bf16_f32 v8, v8, v8
  v_lshlrev_b32 v8, 16, v8
  v_add_f32 v8, v8, v40
  v_cvt_pk_bf16_f32 v8, v8, v8
  s_and_b64 exec, exec, vcc
  s_cbranch_scc0 L_end
  global_store_short v43, v8, s[36:37]
  s_mov_b64 exec, -1
L_end:
  s_endpgm
.section .rodata,"a"
.p2align 6
.amdhsa_kernel recurrent_scan__gqa_block_cached__mixer_token_mlp__decode_kernel
  .amdhsa_next_free_vgpr 256
  .amdhsa_next_free_sgpr 84
  .amdhsa_accum_offset 256
  .amdhsa_group_segment_fixed_size 0
  .amdhsa_kernarg_size 104
  .amdhsa_user_sgpr_count 2
  .amdhsa_user_sgpr_kernarg_segment_ptr 1
  .amdhsa_system_sgpr_workgroup_id_x 1
  .amdhsa_float_denorm_mode_32 3
.end_amdhsa_kernel
```
